```python
import torch

def _softmax(x, axis=-1):
    return torch.softmax(x, dim=axis)
def _gelu(x):
    return torch.nn.functional.gelu(x, approximate="tanh")
def _silu(x):
    return torch.nn.functional.silu(x)
def _sigmoid(x):
    return torch.sigmoid(x)
def _layernorm(x, axis=-1, eps=1e-5):
    m = x.mean(dim=axis, keepdim=True)
    v = x.var(dim=axis, keepdim=True, unbiased=False)
    return (x - m) / torch.sqrt(v + eps)
def _scatter_add(tgt, idx, src, axis=0):
    return tgt.clone().index_add_(axis, idx, src)
def _segment_sum(src, seg, n):
    out = torch.zeros((n,) + src.shape[1:], dtype=src.dtype)
    return out.index_add_(0, seg, src)
def _pad(x, pw):
    flat = tuple(v for pair in reversed(pw) for v in pair)
    return torch.nn.functional.pad(x, flat)

kernel_name = 'gated_mix__ssm_conv_s4d__ssm_conv_h3__prompt'

def setup_inputs():

    _w = (lambda a: (lambda t: t.to(torch.bfloat16) if t.is_floating_point() else t)(torch.as_tensor(a)))
    def _A_setup():
        Bsz, L, D, N = 1, 2048, 512, 128
        return {
            "u": _w((lambda *s: torch.randn(*s, dtype=torch.bfloat16) * 0.05)(Bsz, L, D)),
            "log_A_real": _w((lambda *s: torch.randn(*s, dtype=torch.bfloat16) * 3.2)(D, N) * 0.5),
            "A_imag": _w((lambda *s: torch.randn(*s, dtype=torch.bfloat16) * 0.2)(D, N) * 3.14),
            "C_real": _w((lambda *s: torch.randn(*s, dtype=torch.bfloat16) * 3.2)(D, N) / N ** 0.5),
            "C_imag": _w((lambda *s: torch.randn(*s, dtype=torch.bfloat16) * 3.2)(D, N) / N ** 0.5),
            "log_dt": _w((lambda *s: torch.randn(*s, dtype=torch.bfloat16) * 0.2)(D) * 0.5 - 4.0),
            "D_skip": _w((lambda *s: torch.randn(*s, dtype=torch.bfloat16) * 0.4)(D)),
        }
    _A_in = _A_setup()

    def _B_setup():
        B, S, D = 1, 2048, 512
        ks = 4
        return {
            "q": _w((lambda *s: torch.randn(*s, dtype=torch.bfloat16) * 0.05)(B, S, D)),
            "k": _w((lambda *s: torch.randn(*s, dtype=torch.bfloat16) * 0.8)(B, S, D)),
            "v": _w((lambda *s: torch.randn(*s, dtype=torch.bfloat16) * 0.8)(B, S, D)),
            "shift_k": _w((lambda *s: torch.randn(*s, dtype=torch.bfloat16) * 0.8)(D, ks) * 0.5),
            "ssm_k": _w((lambda *s: torch.randn(*s, dtype=torch.bfloat16) * 0.8)(D, S) * (1.0 / S ** 0.5)),
            "ssm_D": _w((lambda *s: torch.randn(*s, dtype=torch.bfloat16) * 0.8)(D)),
        }
    _B_in = _B_setup()

    return {
        "A_u": _A_in["u"],
        "A_log_A_real": _A_in["log_A_real"],
        "A_A_imag": _A_in["A_imag"],
        "A_C_real": _A_in["C_real"],
        "A_C_imag": _A_in["C_imag"],
        "A_log_dt": _A_in["log_dt"],
        "A_D_skip": _A_in["D_skip"],
        "B_q": _B_in["q"],
        "B_k": _B_in["k"],
        "B_v": _B_in["v"],
        "B_shift_k": _B_in["shift_k"],
        "B_ssm_k": _B_in["ssm_k"],
        "B_ssm_D": _B_in["ssm_D"],
        "gate_w": _w((lambda *s: torch.randn(*s, dtype=torch.bfloat16) * 0.05)(512) * 16.0),
    }

def reference(A_u, A_log_A_real, A_A_imag, A_C_real, A_C_imag, A_log_dt, A_D_skip, B_q, B_k, B_v, B_shift_k, B_ssm_k, B_ssm_D, gate_w):
    def _A_ref(u, log_A_real, A_imag, C_real, C_imag, log_dt, D_skip):
        L = u.shape[1]
        dt = torch.exp(log_dt)
        A = -torch.exp(log_A_real) + 1j * A_imag
        C = (C_real + 1j * C_imag) * dt[:, None]
        pos = (lambda x, dt: x.to(dt))(torch.arange(L), log_dt.dtype)
        P = torch.exp((A * dt[:, None])[:, :, None] * pos[None, None, :])
        K = 2.0 * torch.einsum("dn,dnl->dl", C, P).real
        L2 = 2 * L
        u_t = (lambda x, *d: x.permute(*d))(u, 0, 2, 1)
        Kf = (lambda x, *a, **k: torch.fft.rfft(x.float(), *a, **k))(K, L2)
        Uf = (lambda x, *a, **k: torch.fft.rfft(x.float(), *a, **k))(u_t, L2)
        y = (lambda x, *a, **k: torch.fft.irfft(x, *a, **k).to(torch.bfloat16))(Uf * Kf[None, :, :], L2)[:, :, :L]
        y = (lambda x, *d: x.permute(*d))(y, 0, 2, 1)
        return y + u * D_skip[None, None, :]

    def _B_ref(q, k, v, shift_k, ssm_k, ssm_D):
        B, S, D = q.shape
        ks = shift_k.shape[-1]
        k_pad = _pad(k, ((0, 0), (ks - 1, 0), (0, 0)))
        k_shift = torch.zeros_like(k)
        for t in range(ks):
            k_shift = k_shift + k_pad[:, t:t + S, :] * shift_k[:, ks - 1 - t][None, None, :]
        kv = k_shift * v
        L = 2 * S
        kv_pad = _pad(kv, ((0, 0), (0, S), (0, 0)))
        kf_pad = _pad(ssm_k, ((0, 0), (0, S)))
        kv_f = (lambda x, axes=(-2,-1): torch.fft.rfft2(x.float(), dim=axes))(kv_pad[:, None, :, :], axes=(1, 2))
        kf_f = (lambda x, axes=(-2,-1): torch.fft.rfft2(x.float(), dim=axes))(kf_pad[:, None, :], axes=(1, 2))
        kf_f = (lambda x, *d: x.permute(*d))(kf_f, 1, 2, 0)
        y_f = kv_f * kf_f[None, :, :, :]
        y = (lambda x, s, axes=(-2,-1): torch.fft.irfft2(x, s=s, dim=axes).to(torch.bfloat16))(y_f, (1, L), axes=(1, 2))[:, 0, :S, :]
        y = y + kv * ssm_D[None, None, :]
        return q * y

    x = A_u
    g = _sigmoid((x * gate_w).sum(-1, keepdims=True))
    a = _A_ref(x, A_log_A_real, A_A_imag, A_C_real, A_C_imag, A_log_dt, A_D_skip)
    b = _B_ref(x, B_k, B_v, B_shift_k, B_ssm_k, B_ssm_D)
    return g * a + (1 - g) * b
```

```asm
; @launch grid=(256,1,1) block=(512,1,1) lds=139920
.amdgcn_target "amdgcn-amd-amdhsa--gfx950"
.text
.globl gated_mix__ssm_conv_s4d__ssm_conv_h3__prompt_kernel
.p2align 8
.type gated_mix__ssm_conv_s4d__ssm_conv_h3__prompt_kernel,@function
gated_mix__ssm_conv_s4d__ssm_conv_h3__prompt_kernel:
    s_cmp_ge_u32 s2, 256
    s_cbranch_scc1 Lend
    s_nop 0
    s_load_dwordx16 s[8:23], s[0:1], 0
    s_load_dwordx16 s[24:39], s[0:1], 64
    s_load_dwordx2 s[40:41], s[0:1], 128
    s_mov_b32 s88, 0xffff0000
    s_cmp_ge_u32 s2, 256
    s_cbranch_scc1 Lnopf
    s_getpc_b64 s[68:69]
    v_lshlrev_b32_e64 v49, 4, v0
    v_add_u32 v50, 0x2000, v49
    v_min_u32 v50, Lend-gated_mix__ssm_conv_s4d__ssm_conv_h3__prompt_kernel-16, v50
    s_and_b32 s68, s68, 0xffffff00
    global_load_dwordx4 v[56:59], v49, s[68:69]
    global_load_dwordx4 v[60:63], v50, s[68:69]
Lnopf:
    v_lshrrev_b32 v40, 6, v0
    s_nop 0
    v_readfirstlane_b32 s3, v40
    v_and_b32 v1, 63, v0
    v_and_b32_e64 v2, 15, v0
    v_bfe_u32 v3, v0, 4, 2
    v_lshlrev_b32 v40, 4, v1
    s_and_b32 s4, s2, 7
    s_lshr_b32 s5, s2, 3
    s_lshl_b32 s6, s4, 6
    s_lshl_b32 s7, s5, 1
    s_add_u32 s6, s6, s7
    s_and_b32 s43, s3, 3
    s_cmp_ge_u32 s3, 4
    s_cbranch_scc1 Ltw
    s_lshl_b32 s70, s6, 8
    v_lshlrev_b32 v41, 1, v0
    v_add_u32 v41, s70, v41
    s_lshr_b32 s42, s3, 1
    s_add_u32 s7, s42, s6
    s_lshl_b32 s71, s7, 1
    v_mov_b32 v42, s71
    s_mov_b32 s48, 0x3fb8aa00
    s_mov_b32 s49, 0x36eca570
    s_waitcnt lgkmcnt(0)
    s_nop 0
    global_load_ushort v51, v42, s[18:19]
    global_load_ushort v52, v41, s[10:11]
    global_load_ushort v53, v41, s[12:13]
    global_load_ushort v54, v41, s[14:15]
    global_load_ushort v55, v41, s[16:17]
    v_and_b32 v42, 1, v0
    v_lshlrev_b32 v42, 21, v42
    v_bfe_u32 v43, v0, 1, 2
    v_lshl_add_u32 v42, v43, 16, v42
    s_lshl_b32 s70, s4, 18
    v_add_u32 v42, s70, v42
    v_lshlrev_b32_e64 v43, 19, v43
    global_load_dword v253, v42, s[40:41]
    global_load_dword v254, v43, s[36:37]
    s_barrier
    s_branch Lkw
Ltw:
    s_setprio 3
    v_lshrrev_b32 v44, 3, v1
    v_lshlrev_b32 v44, 10, v44
    v_and_b32 v45, 7, v0
    v_lshl_add_u32 v44, v45, 4, v44
    s_lshl_b32 s70, s5, 16
    s_lshl_b32 s71, s4, 7
    s_add_u32 s70, s70, s71
    s_sub_u32 s71, s70, 0x2000
    v_add_u32 v45, s71, v44
    s_lshl_b32 s71, s43, 14
    s_add_u32 s70, s70, s71
    v_add_u32_e64 v44, s70, v44
    v_add_u32 v41, 0x2000, v44
    s_mul_i32 s70, s43, 2080
    s_lshl_b32 s71, s43, 4
    s_lshl_b64 s[92:93], 0xffff, s71
    v_mov_b32 v43, 6291456
    s_lshl_b32 s94, s4, 9
    s_lshl_b32 s95, s43, 7
    s_add_u32 s94, s94, s95
    v_lshlrev_b32 v46, 4, v3
    v_add_u32 v46, s94, v46
    s_lshl_b32 s94, s2, 13
    s_lshl_b32 s95, s43, 11
    s_add_u32 s94, s94, s95
    v_add_u32 v47, s94, v40
    v_mov_b32 v108, 0
    v_mov_b32 v109, 0
    v_mov_b32 v110, 0
    v_mov_b32 v111, 0
    v_add_u32 v42, 139408, v40
    s_mov_b64 exec, 0xffffffff
    ds_write_b128 v42, v[108:111]
    s_lshr_b32 s94, s43, 1
    s_mul_i32 s94, s94, 16896
    s_and_b32 s95, s43, 1
    s_mul_i32 s95, s95, 4224
    s_add_u32 s94, s94, s95
    v_add_u32 v42, s94, v40
    s_mov_b64 exec, 15
    ds_write_b128 v42, v[108:111] offset:0
    s_mov_b64 exec, -1
    s_waitcnt lgkmcnt(0)
    s_barrier
    s_mov_b32 s44, s24
    s_mov_b32 s45, s25
    s_mov_b32 s46, 0x200000
    s_mov_b32 s47, 0x00020000
    global_load_dwordx4 v[8:11], v46, s[28:29]
    global_load_dwordx4 v[12:15], v46, s[28:29] offset:64
    global_load_dword v4, v43, s[40:41]
    s_add_u32 m0, s70, 106256
    s_nop 0
    global_load_lds_dwordx4 v44, s[24:25]
    s_add_u32 m0, s70, 114576
    s_nop 0
    global_load_lds_dwordx4 v44, s[26:27]
    s_add_u32 m0, s70, 122896
    s_nop 0
    global_load_lds_dwordx4 v44, s[8:9]
    s_add_u32 m0, s70, 107296
    s_nop 0
    global_load_lds_dwordx4 v41, s[24:25]
    s_add_u32 m0, s70, 115616
    s_nop 0
    global_load_lds_dwordx4 v41, s[26:27]
    s_add_u32 m0, s70, 123936
    s_nop 0
    global_load_lds_dwordx4 v41, s[8:9]
    s_mov_b32 m0, 105216
    s_mov_b64 exec, s[92:93]
    buffer_load_dwordx4 v45, s[44:47], 0 offen lds
    s_mov_b64 exec, -1
    v_mov_b32 v48, v47
    s_lshl_b32 s95, s6, 1
    s_load_dword s98, s[20:21], s95
    s_load_dword s99, s[32:33], s95
    s_mov_b32 s52, 0x05040100
    s_mov_b32 s53, 0x07060302
    v_and_b32 v31, 7, v2
    v_sub_u32 v5, 7, v31
    v_mul_u32_u24 v37, 1040, v5
    v_lshrrev_b32_e64 v6, 3, v2
    v_lshl_add_u32 v37, v6, 9, v37
    v_lshl_add_u32 v37, v3, 2, v37
    s_lshl_b32 s94, s43, 5
    s_add_u32 s94, s94, 105216
    v_add_u32 v37, s94, v37
    v_lshl_add_u32 v38, v6, 4, v37
    v_lshl_add_u32 v36, v3, 1, v6
    v_mul_u32_u24 v36, 4096, v36
    v_lshlrev_b32 v5, 4, v5
    v_sub_u32 v36, v36, v5
    s_lshl_b32 s94, s4, 6
    s_lshl_b32 s95, s43, 4
    s_add_u32 s94, s94, s95
    s_mul_i32 s94, s94, 4096
    s_lshl_b32 s95, s5, 7
    s_sub_u32 s94, s94, s95
    s_add_u32 s94, s94, 4080
    v_add_u32 v36, s94, v36
    v_cmp_eq_u32 s[54:55], 1, v6
    s_lshl_b32 s94, s43, 2
    s_add_u32 s94, s94, 139408
    v_mov_b32 v28, s94
    v_mov_b32 v29, 139408
    v_mov_b32 v30, 1
    s_lshl_b32 s94, s43, 3
    v_and_b32 v5, 7, v0
    v_add_u32 v39, s94, v5
    v_lshlrev_b32 v39, 15, v39
    s_lshl_b32 s94, s4, 12
    s_lshr_b32 s95, s5, 3
    s_lshl_b32 s95, s95, 7
    s_add_u32 s94, s94, s95
    s_and_b32 s95, s5, 7
    s_lshl_b32 s96, s95, 2
    s_add_u32 s94, s94, s96
    s_add_u32 s94, s94, 5242880
    v_bfe_u32 v5, v0, 3, 1
    v_mul_u32_u24 v5, 132, v5
    v_add3_u32 v39, v39, v5, s94
    s_cmp_eq_u32 s95, 7
    s_movk_i32 s70, 0xff
    s_cselect_b32 s70, 0xffff, s70
    s_cmp_eq_u32 s5, 31
    s_cselect_b32 s70, 0xff, s70
    s_mul_i32 s94, s43, 9152
    s_add_u32 s94, s94, 37888
    v_add_u32 v5, s94, v40
    s_mov_b32 exec_lo, 0x0fffffff
    s_mov_b32 exec_hi, 0
    ds_write_b128 v5, v[108:111]
    ds_write_b128 v5, v[108:111] offset:4576
    s_mov_b64 exec, -1
    v_subrev_u32 v5, 0x100, v0
    v_lshrrev_b32 v128, 2, v5
    v_lshlrev_b32 v128, 12, v128
    v_and_b32_e64 v6, 3, v5
    v_lshl_add_u32 v128, v6, 4, v128
    v_add_u32 v128, 5243904, v128
    v_add_u32 v129, 0x40000, v128
    v_add_u32 v130, 0x80000, v128
    v_add_u32 v131, 0xc0000, v128
    s_lshl_b32 s95, s6, 1
    s_mov_b32 s56, s36
    s_mov_b32 s57, s37
    s_mov_b32 s58, 0x200000
    s_mov_b32 s59, 0x00020000
    v_lshlrev_b32 v6, 2, v5
    v_add_u32 v120, 70400, v6
    v_sub_u32 v121, 42460, v6
    v_lshlrev_b32 v122, 11, v5
    v_add_u32 v122, s95, v122
    s_lshr_b32 s94, s43, 1
    s_lshl_b32 s94, s94, 4
    s_add_u32 s94, s94, 139408
    v_mov_b32_e64 v123, s94
    v_mov_b32 v132, 139536
    v_min_u32 v43, 8, v2
    v_min_u32 v44, 7, v2
    v_cmp_eq_u32 vcc, 0, v3
    s_nop 1
    v_cndmask_b32 v43, v43, v44, vcc
    v_lshlrev_b32 v43, 2, v43
    v_lshl_add_u32 v43, v3, 7, v43
    s_lshl_b32 s94, s2, 12
    s_add_u32 s94, s94, 5242880
    v_add_u32 v43, s94, v43
    s_lshr_b32 s94, s43, 1
    s_add_u32 s94, s94, s6
    s_mul_i32 s94, s94, 4096
    s_and_b32 s95, s43, 1
    s_mul_i32 s95, s95, 2359424
    s_add_u32 s94, s94, s95
    s_add_u32 s64, s40, s94
    s_addc_u32 s65, s41, 0
    s_mul_i32 s94, s43, 9152
    s_add_u32 s94, s94, 33792
    v_add_u32_e64 v42, s94, v40
    v_cmp_eq_u32 s[92:93], 63, v1
    s_waitcnt lgkmcnt(0)
    s_lshl_b32 s100, s98, 16
    s_and_b32 s101, s98, 0xffff0000
    v_mov_b32 v124, s100
    v_mov_b32 v125, s101
    s_lshl_b32 s100, s99, 16
    s_and_b32 s101, s99, 0xffff0000
    v_mov_b32 v126, s100
    v_mov_b32 v127, s101
    s_lshl_b32 s94, s2, 12
    s_lshl_b32 s95, s43, 7
    s_add_u32 s94, s94, s95
    s_add_u32 s94, s94, 5242880
    v_and_b32 v7, 3, v0
    v_lshlrev_b32 v7, 10, v7
    v_add_u32_e64 v7, s94, v7
    global_load_dword v7, v7, s[40:41] sc1
    s_lshr_b32 s94, s43, 1
    s_add_u32 s95, s94, s6
    s_lshl_b32 s95, s95, 12
    s_add_u32 s60, s30, s95
    s_addc_u32 s61, s31, 0
    s_mov_b32 s62, 4096
    s_mov_b32 s63, 0x00020000
    s_mul_i32 s94, s94, 16896
    s_and_b32 s95, s43, 1
    s_mul_i32 s97, s95, 4224
    s_add_u32 s94, s94, s97
    s_add_u32 s94, s94, 8448
    s_lshl_b32 s95, s95, 2
    v_lshlrev_b32 v35, 2, v1
    s_sub_u32 s96, s95, 64
    v_add_u32 v35, s96, v35
    s_add_u32 m0, s94, 64
    s_nop 0
    s_nop 0
    buffer_load_dwordx4 v40, s[60:63], s95 offen offset:0  lds
    buffer_load_dwordx4 v40, s[60:63], s95 offen offset:1024  lds
    buffer_load_dwordx4 v40, s[60:63], s95 offen offset:2048  lds
    buffer_load_dwordx4 v40, s[60:63], s95 offen offset:3072  lds
    s_mov_b32 m0, s94
    s_mov_b64 exec, 0xffff
    buffer_load_dword v35, s[60:63], 0 offen lds
    s_mov_b64 exec, -1
    s_waitcnt vmcnt(13)
    v_lshlrev_b32 v188, 16, v8
    v_lshlrev_b32 v189, 16, v10
    v_and_b32 v190, s88, v8
    v_and_b32 v191, s88, v10
    v_lshlrev_b32 v192, 16, v9
    v_lshlrev_b32 v193, 16, v11
    v_and_b32 v194, s88, v9
    v_and_b32 v195, s88, v11
    v_lshlrev_b32 v196, 16, v12
    v_lshlrev_b32 v197, 16, v14
    v_and_b32 v198, s88, v12
    v_and_b32 v199, s88, v14
    v_lshlrev_b32 v200, 16, v13
    v_lshlrev_b32 v201, 16, v15
    v_and_b32 v202, s88, v13
    v_and_b32 v203, s88, v15
    v_add_u32 v4, 1, v4
    s_waitcnt vmcnt(6)
    s_nop 0
    ds_write_b32 v28, v30 offset:192
    global_load_dwordx4 v[16:19], v48, s[8:9]
    global_load_dwordx4 v[20:23], v48, s[8:9] offset:1024
    global_load_dwordx4 v[24:27], v40, s[34:35]
    ds_write_b32 v28, v30 offset:192
    s_nop 0
Lsy0:
    ds_read_b128 v[32:35], v29 offset:192
    s_waitcnt lgkmcnt(0)
    v_and_b32 v32, v32, v33
    v_and_b32 v34, v34, v35
    v_and_b32 v32, v32, v34
    v_cmp_ne_u32 vcc, 0, v32
    s_cbranch_vccz Lsy0
    s_nop 0
    ds_read_b32 v140, v38 offset:640
    ds_read_b32 v141, v38 offset:768
    ds_read_b32 v142, v38 offset:896
    ds_read_b32 v143, v37 offset:1040
    ds_read_b32 v144, v37 offset:1168
    ds_read_b32 v145, v37 offset:1296
    ds_read_b32 v146, v37 offset:1424
    ds_read_b32 v147, v37 offset:9360
    ds_read_b32 v148, v37 offset:9488
    ds_read_b32 v149, v37 offset:9616
    ds_read_b32 v150, v37 offset:9744
    ds_read_b32 v151, v37 offset:17680
    ds_read_b32 v152, v37 offset:17808
    ds_read_b32 v153, v37 offset:17936
    ds_read_b32 v154, v37 offset:18064
    s_waitcnt lgkmcnt(0)
    s_nop 0
    ds_read_b32 v156, v38 offset:656
    ds_read_b32 v157, v38 offset:784
    ds_read_b32 v158, v38 offset:912
    ds_read_b32 v159, v37 offset:1056
    ds_read_b32 v160, v37 offset:1184
    ds_read_b32 v161, v37 offset:1312
    ds_read_b32 v162, v37 offset:1440
    ds_read_b32 v163, v37 offset:9376
    ds_read_b32 v164, v37 offset:9504
    ds_read_b32 v165, v37 offset:9632
    ds_read_b32 v166, v37 offset:9760
    ds_read_b32 v167, v37 offset:17696
    ds_read_b32 v168, v37 offset:17824
    ds_read_b32 v169, v37 offset:17952
    ds_read_b32 v170, v37 offset:18080
    v_lshlrev_b32 v72, 16, v140
    v_and_b32 v73, s88, v140
    v_lshlrev_b32 v74, 16, v141
    v_and_b32 v75, s88, v141
    v_lshlrev_b32 v76, 16, v142
    v_and_b32 v77, s88, v142
    v_lshlrev_b32 v78, 16, v143
    v_and_b32 v79, s88, v143
    v_lshlrev_b32 v80, 16, v144
    v_and_b32 v81, s88, v144
    v_lshlrev_b32 v82, 16, v145
    v_and_b32 v83, s88, v145
    v_lshlrev_b32 v84, 16, v146
    v_and_b32 v85, s88, v146
    v_pk_mul_f32 v[94:95], v[72:73], v[194:195]
    v_pk_mul_f32 v[96:97], v[74:75], v[194:195]
    v_pk_mul_f32 v[98:99], v[76:77], v[194:195]
    v_pk_mul_f32 v[100:101], v[78:79], v[194:195]
    v_lshlrev_b32 v86, 16, v147
    v_and_b32 v87, s88, v147
    v_lshlrev_b32 v88, 16, v148
    v_and_b32 v89, s88, v148
    v_lshlrev_b32 v90, 16, v149
    v_and_b32 v91, s88, v149
    v_lshlrev_b32 v92, 16, v150
    v_and_b32 v93, s88, v150
    v_pk_fma_f32 v[94:95], v[74:75], v[192:193], v[94:95]
    v_pk_fma_f32 v[96:97], v[76:77], v[192:193], v[96:97]
    v_pk_fma_f32 v[98:99], v[78:79], v[192:193], v[98:99]
    v_pk_fma_f32 v[100:101], v[80:81], v[192:193], v[100:101]
    v_pk_fma_f32 v[94:95], v[76:77], v[190:191], v[94:95]
    v_pk_fma_f32 v[96:97], v[78:79], v[190:191], v[96:97]
    v_pk_fma_f32 v[98:99], v[80:81], v[190:191], v[98:99]
    v_pk_fma_f32 v[100:101], v[82:83], v[190:191], v[100:101]
    v_pk_fma_f32 v[94:95], v[78:79], v[188:189], v[94:95]
    v_pk_fma_f32 v[96:97], v[80:81], v[188:189], v[96:97]
    v_pk_fma_f32 v[98:99], v[82:83], v[188:189], v[98:99]
    v_pk_fma_f32 v[100:101], v[84:85], v[188:189], v[100:101]
    v_perm_b32 v106, v153, v154, s52
    v_perm_b32 v107, v151, v152, s52
    v_perm_b32 v108, v153, v154, s53
    v_perm_b32 v109, v151, v152, s53
    v_pk_mul_f32 v[94:95], v[94:95], v[86:87]
    v_pk_mul_f32 v[96:97], v[96:97], v[88:89]
    v_pk_mul_f32 v[98:99], v[98:99], v[90:91]
    v_pk_mul_f32 v[100:101], v[100:101], v[92:93]
    s_mov_b64 vcc, s[54:55]
    s_nop 0
    v_cvt_pk_bf16_f32 v102, v100, v98
    v_cvt_pk_bf16_f32 v103, v96, v94
    v_cvt_pk_bf16_f32 v104, v101, v99
    v_cvt_pk_bf16_f32 v105, v97, v95
    v_cndmask_b32_dpp v176, v106, v108, vcc row_ror:8 row_mask:0xf bank_mask:0xf
    v_cndmask_b32_dpp v177, v107, v109, vcc row_ror:8 row_mask:0xf bank_mask:0xf
    v_cndmask_b32_dpp v172, v102, v104, vcc row_ror:8 row_mask:0xf bank_mask:0xf
    v_cndmask_b32_dpp v173, v103, v105, vcc row_ror:8 row_mask:0xf bank_mask:0xf
    s_not_b64 vcc, vcc
    s_nop 0
    v_cndmask_b32_dpp v178, v108, v106, vcc row_ror:8 row_mask:0xf bank_mask:0xf
    v_cndmask_b32_dpp v179, v109, v107, vcc row_ror:8 row_mask:0xf bank_mask:0xf
    v_cndmask_b32_dpp v174, v104, v102, vcc row_ror:8 row_mask:0xf bank_mask:0xf
    v_cndmask_b32_dpp v175, v105, v103, vcc row_ror:8 row_mask:0xf bank_mask:0xf
    v_add_u32 v47, 2359424, v36
    global_store_dwordx4 v36, v[176:179], s[40:41] sc1
    global_store_dwordx4 v47, v[172:175], s[40:41] sc1
    v_add_u32 v36, 32768, v36
    s_waitcnt lgkmcnt(0)
    v_lshlrev_b32 v72, 16, v156
    v_and_b32 v73, s88, v156
    v_lshlrev_b32 v74, 16, v157
    v_and_b32 v75, s88, v157
    v_lshlrev_b32 v76, 16, v158
    v_and_b32 v77, s88, v158
    v_lshlrev_b32 v78, 16, v159
    v_and_b32 v79, s88, v159
    v_lshlrev_b32 v80, 16, v160
    v_and_b32 v81, s88, v160
    v_lshlrev_b32 v82, 16, v161
    v_and_b32 v83, s88, v161
    v_lshlrev_b32 v84, 16, v162
    v_and_b32_e64 v85, s88, v162
    v_pk_mul_f32 v[94:95], v[72:73], v[202:203]
    v_pk_mul_f32 v[96:97], v[74:75], v[202:203]
    v_pk_mul_f32 v[98:99], v[76:77], v[202:203]
    v_pk_mul_f32 v[100:101], v[78:79], v[202:203]
    v_lshlrev_b32 v86, 16, v163
    v_and_b32 v87, s88, v163
    v_lshlrev_b32 v88, 16, v164
    v_and_b32 v89, s88, v164
    v_lshlrev_b32 v90, 16, v165
    v_and_b32 v91, s88, v165
    v_lshlrev_b32 v92, 16, v166
    v_and_b32 v93, s88, v166
    v_pk_fma_f32 v[94:95], v[74:75], v[200:201], v[94:95]
    v_pk_fma_f32 v[96:97], v[76:77], v[200:201], v[96:97]
    v_pk_fma_f32 v[98:99], v[78:79], v[200:201], v[98:99]
    v_pk_fma_f32 v[100:101], v[80:81], v[200:201], v[100:101]
    v_pk_fma_f32 v[94:95], v[76:77], v[198:199], v[94:95]
    v_pk_fma_f32 v[96:97], v[78:79], v[198:199], v[96:97]
    v_pk_fma_f32 v[98:99], v[80:81], v[198:199], v[98:99]
    v_pk_fma_f32 v[100:101], v[82:83], v[198:199], v[100:101]
    v_pk_fma_f32 v[94:95], v[78:79], v[196:197], v[94:95]
    v_pk_fma_f32 v[96:97], v[80:81], v[196:197], v[96:97]
    v_pk_fma_f32 v[98:99], v[82:83], v[196:197], v[98:99]
    v_pk_fma_f32 v[100:101], v[84:85], v[196:197], v[100:101]
    v_perm_b32 v106, v169, v170, s52
    v_perm_b32 v107, v167, v168, s52
    v_perm_b32 v108, v169, v170, s53
    v_perm_b32 v109, v167, v168, s53
    v_pk_mul_f32 v[94:95], v[94:95], v[86:87]
    v_pk_mul_f32 v[96:97], v[96:97], v[88:89]
    v_pk_mul_f32 v[98:99], v[98:99], v[90:91]
    v_pk_mul_f32 v[100:101], v[100:101], v[92:93]
    s_mov_b64 vcc, s[54:55]
    s_nop 0
    v_cvt_pk_bf16_f32 v102, v100, v98
    v_cvt_pk_bf16_f32 v103, v96, v94
    v_cvt_pk_bf16_f32 v104, v101, v99
    v_cvt_pk_bf16_f32 v105, v97, v95
    v_cndmask_b32_dpp v184, v106, v108, vcc row_ror:8 row_mask:0xf bank_mask:0xf
    v_cndmask_b32_dpp v185, v107, v109, vcc row_ror:8 row_mask:0xf bank_mask:0xf
    v_cndmask_b32_dpp v180, v102, v104, vcc row_ror:8 row_mask:0xf bank_mask:0xf
    v_cndmask_b32_dpp v181, v103, v105, vcc row_ror:8 row_mask:0xf bank_mask:0xf
    s_not_b64 vcc, vcc
    s_nop 0
    v_cndmask_b32_dpp v186, v108, v106, vcc row_ror:8 row_mask:0xf bank_mask:0xf
    v_cndmask_b32_dpp v187, v109, v107, vcc row_ror:8 row_mask:0xf bank_mask:0xf
    v_cndmask_b32_dpp v182, v104, v102, vcc row_ror:8 row_mask:0xf bank_mask:0xf
    v_cndmask_b32_dpp v183, v105, v103, vcc row_ror:8 row_mask:0xf bank_mask:0xf
    v_add_u32 v47, 2359424, v36
    global_store_dwordx4 v36, v[184:187], s[40:41] sc1
    global_store_dwordx4 v47, v[180:183], s[40:41] sc1
    s_waitcnt vmcnt(4)
    s_nop 0
    ds_write_b32 v28, v30 offset:256
    v_dot2_f32_bf16 v64, v16, v24, 0
    v_dot2_f32_bf16 v65, v17, v25, 0
    v_dot2_f32_bf16 v66, v20, v24, 0
    v_dot2_f32_bf16 v67, v21, v25, 0
    v_dot2_f32_bf16 v64, v18, v26, v64
    v_dot2_f32_bf16 v65, v19, v27, v65
    v_dot2_f32_bf16 v66, v22, v26, v66
    v_dot2_f32_bf16 v67, v23, v27, v67
    s_lshl_b32 s94, s2, 12
    s_lshl_b32 s95, s43, 4
    s_add_u32 s94, s94, s95
    s_add_u32 s94, s94, 5243904
    v_add_f32 v64, v64, v65
    v_add_f32 v66, v66, v67
    v_mov_b32 v47, s94
    v_add_f32_dpp v64, v64, v64 row_shr:1 row_mask:0xf bank_mask:0xf bound_ctrl:0
    v_add_f32_dpp v66, v66, v66 row_shr:1 row_mask:0xf bank_mask:0xf bound_ctrl:0
    s_nop 0
    v_add_f32_dpp v64, v64, v64 row_shr:2 row_mask:0xf bank_mask:0xf bound_ctrl:0
    v_add_f32_dpp v66, v66, v66 row_shr:2 row_mask:0xf bank_mask:0xf bound_ctrl:0
    s_nop 0
    v_add_f32_dpp v64, v64, v64 row_shr:4 row_mask:0xf bank_mask:0xf bound_ctrl:0
    v_add_f32_dpp v66, v66, v66 row_shr:4 row_mask:0xf bank_mask:0xf bound_ctrl:0
    s_nop 0
    v_add_f32_dpp v64, v64, v64 row_shr:8 row_mask:0xf bank_mask:0xf bound_ctrl:0
    v_add_f32_dpp v66, v66, v66 row_shr:8 row_mask:0xf bank_mask:0xf bound_ctrl:0
    s_nop 0
    v_add_f32_dpp v64, v64, v64 row_bcast:15 row_mask:0xa bank_mask:0xf
    v_add_f32_dpp v66, v66, v66 row_bcast:15 row_mask:0xa bank_mask:0xf
    s_nop 0
    s_nop 0
    v_add_f32_dpp v64, v64, v64 row_bcast:31 row_mask:0xc bank_mask:0xf
    v_add_f32_dpp v66, v66, v66 row_bcast:31 row_mask:0xc bank_mask:0xf
    v_cvt_pk_bf16_f32 v64, 0, v64
    v_cvt_pk_bf16_f32 v66, 0, v66
    v_mul_f32 v64, 0xbfb8aa3b, v64
    v_mul_f32 v66, 0xbfb8aa3b, v66
    v_exp_f32 v64, v64
    v_exp_f32 v66, v66
    v_add_f32 v64, 1.0, v64
    v_add_f32 v66, 1.0, v66
    v_rcp_f32 v64, v64
    v_rcp_f32 v66, v66
    v_mov_b32 v65, v4
    v_mov_b32 v67, v4
    v_cvt_pk_bf16_f32 v64, v64, 0
    v_cvt_pk_bf16_f32 v66, v66, 0
    s_mov_b32 exec_lo, 0
    s_brev_b32 exec_hi, 1
    global_store_dwordx4 v47, v[64:67], s[40:41] sc1
    s_mov_b32 exec_lo, s70
    s_mov_b32 exec_hi, 0
    s_waitcnt vmcnt(1)
    global_store_dword v39, v4, s[40:41]
    s_mov_b64 exec, -1
    s_mov_b32 s94, 0
    s_mov_b64 s[66:67], -1
Lpoll:
    global_load_dword v47, v43, s[40:41] sc1
    s_add_u32 s94, s94, 1
    s_waitcnt vmcnt(0)
    v_cmp_ne_u32 vcc, v4, v47
    s_nop 0
    s_and_b64 s[66:67], s[66:67], vcc
    s_cmp_le_u32 s94, 15
    s_cbranch_scc1 Lpn0
    s_mov_b32 exec_lo, s70
    s_mov_b32 exec_hi, 0
    global_store_dword v39, v4, s[40:41] offset:2048 sc1
    s_mov_b64 exec, -1
    global_load_dword v47, v43, s[40:41] offset:2048 sc1
    s_waitcnt vmcnt(0)
    v_cmp_ne_u32 vcc, v4, v47
    s_nop 0
    s_and_b64 s[66:67], s[66:67], vcc
    s_cmp_lt_u32 s94, 0x800000
    s_cbranch_scc1 Lpn0
    s_mov_b64 s[66:67], 0
Lpn0:
    s_and_b32 s95, s66, 0xffff
    s_cbranch_scc1 Lpoll
    global_load_dwordx4 v[64:67], v40, s[64:65] offset:3072 sc1
    global_load_dword v68, v40, s[64:65] offset:3088 sc1
    s_mov_b32 s96, 0
    s_cmp_eq_u64 s[66:67], 0
    s_cbranch_scc1 Lpall
Lp2:
    global_load_dword v47, v43, s[40:41] sc1
    s_add_u32 s94, s94, 1
    s_waitcnt vmcnt(0)
    v_cmp_ne_u32 vcc, v4, v47
    s_nop 0
    s_and_b64 s[66:67], s[66:67], vcc
    s_cmp_le_u32 s94, 15
    s_cbranch_scc1 Lpn1
    s_mov_b32 exec_lo, s70
    s_mov_b32 exec_hi, 0
    global_store_dword v39, v4, s[40:41] offset:2048 sc1
    s_mov_b64 exec, -1
    global_load_dword v47, v43, s[40:41] offset:2048 sc1
    s_waitcnt vmcnt(0)
    v_cmp_ne_u32 vcc, v4, v47
    s_nop 0
    s_and_b64 s[66:67], s[66:67], vcc
    s_cmp_lt_u32 s94, 0x800000
    s_cbranch_scc1 Lpn1
    s_mov_b64 s[66:67], 0
Lpn1:
    s_cmp_lg_u32 s96, 0
    s_cbranch_scc1 Lp3
    s_mov_b32 s96, 1
    s_nop 0
    v_cndmask_b32 v68, v68, 0, s[92:93]
    ds_write_b128 v42, v[64:67] offset:7648
    v_alignbit_b32 v8, v65, v64, 16
    v_alignbit_b32 v9, v66, v65, 16
    v_alignbit_b32 v10, v67, v66, 16
    v_alignbit_b32 v11, v68, v67, 16
    ds_write_b128 v42, v[8:11] offset:3072
    ds_write_b32 v28, v30 offset:128
    s_nop 2
Lp3:
    s_cmp_lg_u64 s[66:67], 0
    s_cbranch_scc1 Lp2
Lpall:
    s_nop 0
    global_load_dwordx4 v[72:75], v40, s[64:65] offset:2048 sc1
    global_load_dword v76, v40, s[64:65] offset:2064 sc1
    global_load_dwordx4 v[80:83], v40, s[64:65] offset:1024 sc1
    global_load_dword v84, v40, s[64:65] offset:1040 sc1
    global_load_dwordx4 v[88:91], v40, s[64:65] offset:0 sc1
    global_load_dword v92, v40, s[64:65] offset:16 sc1
    global_load_dwordx4 v[96:99], v128, s[40:41] sc1
    global_load_dwordx4 v[100:103], v129, s[40:41] sc1
    global_load_dwordx4 v[104:107], v130, s[40:41] sc1
    global_load_dwordx4 v[108:111], v131, s[40:41] sc1
    s_cmp_lg_u32 s96, 0
    s_cbranch_scc1 Ls0d
    s_waitcnt vmcnt(10)
    s_nop 0
    v_cndmask_b32 v68, v68, 0, s[92:93]
    ds_write_b128 v42, v[64:67] offset:7648
    v_alignbit_b32 v8, v65, v64, 16
    v_alignbit_b32 v9, v66, v65, 16
    v_alignbit_b32 v10, v67, v66, 16
    v_alignbit_b32 v11, v68, v67, 16
    ds_write_b128 v42, v[8:11] offset:3072
    ds_write_b32 v28, v30 offset:128
    s_nop 2
Ls0d:
    s_waitcnt vmcnt(8)
    ds_write_b128 v42, v[72:75] offset:6624
    v_alignbit_b32 v12, v73, v72, 16
    v_alignbit_b32 v13, v74, v73, 16
    v_alignbit_b32 v14, v75, v74, 16
    v_alignbit_b32 v15, v76, v75, 16
    ds_write_b128 v42, v[12:15] offset:2048
    ds_write_b32 v28, v30 offset:144
    s_waitcnt vmcnt(6)
    s_nop 0
    ds_write_b128 v42, v[80:83] offset:5600
    v_alignbit_b32 v16, v81, v80, 16
    v_alignbit_b32 v17, v82, v81, 16
    v_alignbit_b32 v18, v83, v82, 16
    v_alignbit_b32 v19, v84, v83, 16
    ds_write_b128 v42, v[16:19] offset:1024
    ds_write_b32 v28, v30 offset:160
    s_waitcnt vmcnt(4)
    s_nop 0
    ds_write_b128 v42, v[88:91] offset:4576
    v_alignbit_b32 v20, v89, v88, 16
    v_alignbit_b32 v21, v90, v89, 16
    v_alignbit_b32 v22, v91, v90, 16
    v_alignbit_b32 v23, v92, v91, 16
    ds_write_b128 v42, v[20:23] offset:0
    ds_write_b32 v28, v30 offset:176
    s_setprio 0
    s_mov_b32 exec_lo, s70
    s_mov_b32 exec_hi, 0
    global_store_dword v39, v4, s[40:41] offset:2048 sc1
    s_mov_b64 exec, -1
    s_mov_b32 s94, 0
    s_waitcnt vmcnt(1)
    s_branch Lgchk
Lgld:
    s_nop 0
    global_load_dwordx4 v[96:99], v128, s[40:41] sc1
    global_load_dwordx4 v[100:103], v129, s[40:41] sc1
    global_load_dwordx4 v[104:107], v130, s[40:41] sc1
    global_load_dwordx4 v[108:111], v131, s[40:41] sc1
    s_waitcnt vmcnt(0)
Lgchk:
    v_xor_b32 v20, v4, v97
    v_xor_b32 v21, v4, v99
    v_or_b32 v20, v20, v21
    v_xor_b32 v21, v4, v101
    v_or_b32 v20, v20, v21
    v_xor_b32 v21, v4, v103
    v_or_b32 v20, v20, v21
    v_xor_b32 v21, v4, v105
    v_or_b32 v20, v20, v21
    v_xor_b32 v21, v4, v107
    v_or_b32 v20, v20, v21
    v_xor_b32 v21, v4, v109
    v_or_b32 v20, v20, v21
    v_xor_b32 v21, v4, v111
    v_or_b32 v20, v20, v21
    v_cmp_ne_u32 vcc, 0, v20
    s_cbranch_vccz Lgok
    s_add_u32 s94, s94, 1
    s_cmp_lt_u32 s94, 0x200000
    s_cbranch_scc1 Lgld
    s_nop 0
Lgok:
    s_nop 0
    v_lshl_or_b32 v20, v98, 16, v96
    ds_write_b32 v120, v20 offset:16384
    v_lshl_or_b32 v21, v102, 16, v100
    ds_write_b32 v120, v21 offset:17408
    v_lshl_or_b32 v22, v106, 16, v104
    ds_write_b32 v120, v22 offset:18432
    v_lshl_or_b32 v23, v110, 16, v108
    ds_write_b32 v120, v23 offset:19456
    s_mov_b32 s60, 0
    s_nop 2
Lepi:
    ds_read_b128 v[20:23], v132
    s_waitcnt lgkmcnt(0)
    v_and_b32 v20, v20, v21
    v_and_b32 v22, v22, v23
    v_and_b32 v20, v20, v22
    v_cmp_ne_u32 vcc, 0, v20
    s_cbranch_vccz Lepi
    ds_read_b32 v28, v121 offset:0
    ds_read_b32 v29, v121 offset:9152
    ds_read_b32 v30, v121 offset:18304
    ds_read_b32 v31, v121 offset:27456
    ds_read_b32 v32, v120 offset:16384
    s_waitcnt lgkmcnt(0)
    v_and_b32 v34, s88, v28
    v_lshlrev_b32 v36, 16, v28
    v_and_b32 v38, s88, v29
    v_lshlrev_b32 v40, 16, v29
    v_and_b32 v35, s88, v30
    v_lshlrev_b32 v37, 16, v30
    v_and_b32 v39, s88, v31
    v_lshlrev_b32 v41, 16, v31
    v_lshlrev_b32 v50, 16, v32
    v_and_b32 v51, s88, v32
    v_mul_f32 v52, v34, v50
    v_mul_f32 v53, v35, v50
    v_mul_f32 v54, v36, v51
    v_mul_f32 v55, v37, v51
    v_mul_f32 v38, v38, v126
    v_mul_f32 v39, v39, v127
    v_mul_f32 v40, v40, v126
    v_mul_f32 v41, v41, v127
    v_sub_f32 v34, v34, v52
    v_sub_f32 v35, v35, v53
    v_sub_f32 v36, v36, v54
    v_sub_f32 v37, v37, v55
    v_mul_f32 v52, v52, v124
    v_mul_f32 v53, v53, v125
    v_mul_f32 v54, v54, v124
    v_mul_f32 v55, v55, v125
    v_fmac_f32 v52, v34, v38
    v_fmac_f32 v53, v35, v39
    v_fmac_f32 v54, v36, v40
    v_fmac_f32 v55, v37, v41
    s_nop 4
Lyw:
    ds_read_b128 v[20:23], v123
    s_waitcnt lgkmcnt(0)
    v_and_b32 v20, v20, v21
    v_and_b32 v22, v22, v23
    v_and_b32 v20, v20, v22
    v_cmp_ne_u32 vcc, 0, v20
    s_cbranch_vccnz Lgo
    s_sleep 1
    s_branch Lyw
Lgo:
    ds_read_b32 v24, v120 offset:0
    ds_read_b32 v25, v120 offset:4096
    ds_read_b32 v26, v120 offset:8192
    ds_read_b32 v27, v120 offset:12288
    v_add_u32 v120, 0x400, v120
    v_subrev_u32 v121, 0x400, v121
    v_add_u32 v123, 32, v123
    v_add_u32 v132, 16, v132
    s_waitcnt lgkmcnt(0)
    v_lshlrev_b32 v42, 16, v24
    v_and_b32 v44, s88, v24
    v_lshlrev_b32 v46, 16, v25
    v_and_b32 v48, s88, v25
    v_lshlrev_b32 v43, 16, v26
    v_and_b32 v45, s88, v26
    v_lshlrev_b32 v47, 16, v27
    v_and_b32 v49, s88, v27
    v_fmac_f32 v52, v42, v50
    v_fmac_f32 v53, v43, v50
    v_fmac_f32 v54, v44, v51
    v_fmac_f32 v55, v45, v51
    v_fmac_f32 v52, v46, v34
    v_fmac_f32 v53, v47, v35
    v_fmac_f32 v54, v48, v36
    v_fmac_f32 v55, v49, v37
    s_nop 0
    v_cvt_pk_bf16_f32 v58, v52, v53
    v_cvt_pk_bf16_f32 v59, v54, v55
    buffer_store_dword v58, v122, s[56:59], s60 offen
    buffer_store_dword v59, v122, s[56:59], s60 offen offset:1024
    s_add_u32 s60, s60, 0x80000
    s_cmp_lt_u32 s60, 0x200000
    s_nop 0
    s_cbranch_scc1 Lepi
    s_cmp_lg_u32 s2, 0
    s_cbranch_scc1 Lfin
    s_barrier
    s_cmp_lg_u32 s3, 4
    s_cbranch_scc1 Lfin
    v_mov_b32 v20, 6291456
    s_mov_b64 exec, 1
    global_store_dword v20, v4, s[40:41] sc1
Lfin:
    s_endpgm
Lkw:
    s_and_b32 s44, s3, 1
    v_lshrrev_b32 v41, 1, v0
    v_lshlrev_b32 v41, 4, v41
    v_and_b32_e64 v46, 1, v0
    v_lshl_add_u32 v41, v46, 2, v41
    v_add_u32 v41, 131216, v41
    s_mov_b32 s50, 0x41600000
    v_lshlrev_b32 v10, 3, v2
    v_cvt_f32_u32 v5, v10
    v_subrev_u32 v10, 8, v2
    v_lshlrev_b32 v11, 9, v10
    v_lshlrev_b32_e64 v10, 2, v10
    v_add_u32 v10, 0x200, v10
    v_cmp_gt_u32 vcc, 10, v2
    s_nop 1
    v_cndmask_b32 v10, v11, v10, vcc
    v_cmp_gt_u32 vcc, 8, v2
    s_nop 1
    v_cndmask_b32 v10, v10, v2, vcc
    v_cvt_f32_u32 v6, v10
    s_lshl_b32 s94, s3, 9
    s_add_u32 s94, s94, 131216
    v_lshlrev_b32 v7, 5, v3
    v_add_u32 v7, s94, v7
    v_mov_b32 v33, v5
    v_mov_b32 v32, v5
    v_mov_b32 v34, v6
    v_mov_b32 v35, v6
    v_mov_b32 v36, s50
    v_mov_b32 v37, s50
    s_mov_b32 s51, 0
    s_lshl_b32 s94, s3, 2
    s_add_u32 s94, s94, 139408
    v_mov_b32 v26, s94
    s_lshl_b32 s94, s42, 3
    s_add_u32 s94, s94, 139408
    v_mov_b32 v27, s94
    v_mov_b32 v28, 1
    v_mov_b32 v148, 0
    v_mov_b32 v149, 0
    v_mov_b32 v150, 0
    v_mov_b32 v151, 0
    v_mov_b32 v152, 0
    v_mov_b32 v153, 0
    v_mov_b32 v154, 0
    v_mov_b32 v155, 0
    v_mov_b32 v156, 0
    v_mov_b32 v157, 0
    v_mov_b32 v158, 0
    v_mov_b32 v159, 0
    v_mov_b32 v160, 0
    v_mov_b32 v161, 0
    v_mov_b32 v162, 0
    v_mov_b32 v163, 0
    s_mul_i32 s45, s42, 3072
    s_add_u32 s45, s45, 99072
    v_lshlrev_b32_e64 v29, 2, v1
    v_add_u32 v29, 2816, v29
    v_lshlrev_b32_e64 v10, 5, v2
    v_lshl_add_u32 v10, v3, 4, v10
    v_lshrrev_b32_e64 v11, 1, v10
    v_add_u32 v11, 0x400, v11
    v_lshlrev_b32_e64 v42, 3, v2
    v_add_u32 v42, 1536, v42
    v_lshlrev_b32_e64 v43, 2, v2
    v_add_u32 v43, 2048, v43
    v_cmp_eq_u32 vcc, 2, v3
    v_cmp_eq_u32 s[92:93], 3, v3
    s_nop 0
    v_cndmask_b32 v200, v10, v42, vcc
    v_add_u32 v44, 0x200, v43
    v_cndmask_b32 v200, v200, v44, s[92:93]
    v_cndmask_b32 v201, v10, v42, vcc
    v_add_u32_e64 v201, 4, v201
    v_cndmask_b32 v201, v201, v29, s[92:93]
    v_add_u32 v44, 8, v10
    v_cndmask_b32 v202, v44, v43, vcc
    v_cndmask_b32 v202, v202, v29, s[92:93]
    v_add_u32_e64 v44, 12, v10
    v_add_u32 v45, 0x100, v43
    v_cndmask_b32 v203, v44, v45, vcc
    v_cndmask_b32 v203, v203, v29, s[92:93]
    v_mov_b32 v44, 0x200
    v_mov_b32 v45, 0x80
    v_cndmask_b32 v45, v44, v45, vcc
    v_cndmask_b32 v47, v45, 64, s[92:93]
    v_cndmask_b32 v45, v45, 0, s[92:93]
    v_cndmask_b32 v44, v44, 64, vcc
    v_cndmask_b32 v44, v44, 0, s[92:93]
    v_add_u32 v204, v200, v47
    v_add_u32 v205, v201, v45
    v_add_u32 v206, v202, v44
    v_add_u32 v207, v203, v44
    v_add_u32 v208, v204, v47
    v_add_u32 v209, v205, v45
    v_add_u32 v210, v206, v44
    v_add_u32 v211, v207, v44
    v_add_u32 v212, v208, v47
    v_add_u32 v213, v209, v45
    v_add_u32 v214, v210, v44
    v_add_u32 v215, v211, v44
    v_cmp_gt_u32 vcc, 2, v3
    s_nop 1
    v_cndmask_b32 v208, v208, v11, vcc
    v_cndmask_b32 v209, v209, v29, vcc
    v_add_u32 v44, 4, v11
    v_cndmask_b32 v210, v210, v44, vcc
    v_cndmask_b32 v211, v211, v29, vcc
    v_add_u32 v44, 0x100, v11
    v_cndmask_b32 v212, v212, v44, vcc
    v_cndmask_b32 v213, v213, v29, vcc
    v_add_u32 v44, 0x104, v11
    v_cndmask_b32 v214, v214, v44, vcc
    v_cndmask_b32 v215, v215, v29, vcc
    s_cmp_eq_u32 s44, 0
    s_cselect_b64 s[92:93], -1, 0
    v_cndmask_b32 v200, v208, v200, s[92:93]
    v_add_u32 v200, s45, v200
    v_cndmask_b32 v201, v209, v201, s[92:93]
    v_add_u32_e64 v201, s45, v201
    v_cndmask_b32 v202, v210, v202, s[92:93]
    v_add_u32_e64 v202, s45, v202
    v_cndmask_b32 v203, v211, v203, s[92:93]
    v_add_u32_e64 v203, s45, v203
    v_cndmask_b32 v204, v212, v204, s[92:93]
    v_add_u32_e64 v204, s45, v204
    v_cndmask_b32 v205, v213, v205, s[92:93]
    v_add_u32_e64 v205, s45, v205
    v_cndmask_b32 v206, v214, v206, s[92:93]
    v_add_u32_e64 v206, s45, v206
    v_cndmask_b32 v207, v215, v207, s[92:93]
    v_add_u32_e64 v207, s45, v207
    v_and_b32 v10, 0x7f, v0
    v_lshlrev_b32_e64 v10, 1, v10
    s_sub_u32 s94, s45, 68096
    v_add_u32 v20, 256, v10
    v_cvt_f32_u32_e64 v20, v20
    v_cvt_pk_bf16_f32 v20, v20, 0
    v_lshl_add_u32 v20, v20, 2, s94
    v_add_u32 v21, 257, v10
    v_cvt_f32_u32_e64 v21, v21
    v_cvt_pk_bf16_f32 v21, v21, 0
    v_lshl_add_u32 v21, v21, 2, s94
    v_add_u32 v22, 512, v10
    v_cvt_f32_u32_e64 v22, v22
    v_cvt_pk_bf16_f32 v22, v22, 0
    v_lshl_add_u32 v22, v22, 2, s94
    v_add_u32 v23, 513, v10
    v_cvt_f32_u32_e64 v23, v23
    v_cvt_pk_bf16_f32 v23, v23, 0
    v_lshl_add_u32 v23, v23, 2, s94
    v_add_u32 v24, 1024, v10
    v_cvt_f32_u32_e64 v24, v24
    v_cvt_pk_bf16_f32 v24, v24, 0
    v_lshl_add_u32 v24, v24, 2, s94
    v_add_u32 v25, 1025, v10
    v_cvt_f32_u32_e64 v25, v25
    v_cvt_pk_bf16_f32 v25, v25, 0
    v_lshl_add_u32 v25, v25, 2, s94
    s_waitcnt vmcnt(2)
    v_lshlrev_b32 v51, 16, v51
    v_lshlrev_b32 v52, 16, v52
    v_lshlrev_b32 v53, 16, v53
    v_lshlrev_b32 v54, 16, v54
    v_lshlrev_b32 v55, 16, v55
    v_max_f32 v45, |v54|, |v55|
    v_mul_f32 v42, s48, v51
    v_rndne_f32 v43, v42
    v_sub_f32_e64 v42, v42, v43
    v_fma_f32 v42, v51, s49, v42
    v_exp_f32 v42, v42
    v_cvt_i32_f32 v43, v43
    v_ldexp_f32 v42, v42, v43
    v_cvt_pk_bf16_f32 v51, 0, v42
    v_max_f32_dpp v45, v45, v45 row_shr:1 row_mask:0xf bank_mask:0xf
    s_nop 1
    v_max_f32_dpp v45, v45, v45 row_shr:2 row_mask:0xf bank_mask:0xf
    v_mul_f32 v42, s48, v52
    v_rndne_f32 v43, v42
    v_sub_f32 v42, v42, v43
    v_fma_f32 v42, v52, s49, v42
    v_exp_f32 v42, v42
    v_cvt_i32_f32 v43, v43
    v_ldexp_f32 v42, v42, v43
    v_cvt_pk_bf16_f32 v52, 0, v42
    v_max_f32_dpp v45, v45, v45 row_shr:4 row_mask:0xf bank_mask:0xf
    s_nop 1
    v_max_f32_dpp v45, v45, v45 row_shr:8 row_mask:0xf bank_mask:0xf
    v_mul_f32 v52, v52, v51
    v_mul_f32_e64 v53, v53, v51
    v_max_f32_dpp v45, v45, v45 row_bcast:15 row_mask:0xa bank_mask:0xf
    v_mul_f32 v64, 0xbfb8aa3b, v52
    v_mul_f32_e64 v65, 0x3e22f983, v53
    v_max_f32_dpp v45, v45, v45 row_bcast:31 row_mask:0xc bank_mask:0xf
    v_mul_f32 v68, 0x43000000, v65
    v_mul_f32 v69, 0x43000000, v64
    v_readlane_b32 s94, v45, 63
    v_fract_f32 v68, v68
    v_exp_f32 v69, v69
    v_cos_f32 v70, v68
    v_sin_f32 v71, v68
    s_lshr_b32 s94, s94, 23
    s_max_u32 s94, s94, 13
    s_sub_u32 s95, 267, s94
    s_lshl_b32 s95, s95, 23
    s_sub_i32 s94, s94, 153
    v_mul_f32 v66, s95, v54
    v_mul_f32_e64 v67, s95, v55
    v_ldexp_f32 v9, v51, s94
    v_mul_f32 v70, v69, v70
    v_mul_f32 v71, v69, v71
    v_rndne_f32 v74, v65
    v_sub_f32 v65, v65, v74
    v_mul_f32 v72, v70, v70
    v_mul_f32 v73, v70, v71
    v_fma_f32 v72, -v71, v71, v72
    v_add_f32_e64 v73, v73, v73
    ds_write2_b32 v41, v64, v65 offset0:0 offset1:2
    v_add_u32 v46, 0x800, v41
    ds_write2_b32 v46, v66, v67 offset0:0 offset1:2
    v_add_u32 v46, 0x1000, v41
    ds_write2_b32 v46, v70, v71 offset0:0 offset1:2
    v_add_u32 v46, 0x1800, v41
    ds_write2_b32 v46, v72, v73 offset0:0 offset1:2
    s_waitcnt lgkmcnt(0)
    s_nop 2
    ds_read_b128 v[64:67], v7 offset:0
    ds_read_b128 v[68:71], v7 offset:2048
    ds_read_b128 v[72:75], v7 offset:4096
    ds_read_b128 v[76:79], v7 offset:6144
    ds_read_b128 v[80:83], v7 offset:16
    ds_read_b128 v[84:87], v7 offset:2064
    ds_read_b128 v[88:91], v7 offset:4112
    ds_read_b128 v[92:95], v7 offset:6160
Lkgen:
    s_waitcnt lgkmcnt(0)
    s_nop 0
    ds_read_b128 v[164:167], v7 offset:128
    ds_read_b128 v[168:171], v7 offset:2176
    ds_read_b128 v[172:175], v7 offset:4224
    ds_read_b128 v[176:179], v7 offset:6272
    ds_read_b128 v[180:183], v7 offset:144
    ds_read_b128 v[184:187], v7 offset:2192
    ds_read_b128 v[188:191], v7 offset:4240
    ds_read_b128 v[192:195], v7 offset:6288
    v_pk_mul_f32 v[110:111], v[66:67], v[34:35]
    v_pk_mul_f32 v[130:131], v[82:83], v[34:35]
    v_pk_mul_f32 v[108:109], v[66:67], v[32:33]
    v_pk_mul_f32 v[128:129], v[82:83], v[32:33]
    v_pk_fma_f32 v[112:113], v[64:65], v[32:33], v[36:37]
    v_pk_fma_f32 v[132:133], v[80:81], v[32:33], v[36:37]
    v_pk_mul_f32 v[114:115], v[64:65], v[34:35]
    v_pk_mul_f32 v[134:135], v[80:81], v[34:35]
    v_fract_f32 v110, v110
    v_fract_f32 v111, v111
    v_fract_f32 v130, v130
    v_fract_f32 v131, v131
    v_exp_f32 v112, v112
    v_exp_f32 v113, v113
    v_exp_f32 v132, v132
    v_exp_f32 v133, v133
    v_cos_f32 v116, v108
    v_cos_f32 v117, v109
    v_cos_f32 v136, v128
    v_cos_f32 v137, v129
    v_sin_f32 v118, v108
    v_sin_f32 v119, v109
    v_sin_f32 v138, v128
    v_sin_f32 v139, v129
    v_cos_f32 v120, v110
    v_cos_f32 v121, v111
    v_cos_f32 v140, v130
    v_cos_f32 v141, v131
    v_pk_mul_f32 v[116:117], v[112:113], v[116:117]
    v_pk_mul_f32 v[136:137], v[132:133], v[136:137]
    v_pk_mul_f32 v[118:119], v[112:113], v[118:119]
    v_pk_mul_f32 v[138:139], v[132:133], v[138:139]
    v_sin_f32 v122, v110
    v_sin_f32 v123, v111
    v_sin_f32 v142, v130
    v_sin_f32 v143, v131
    v_pk_mul_f32 v[124:125], v[116:117], v[72:73]
    v_pk_mul_f32 v[144:145], v[136:137], v[88:89]
    v_pk_mul_f32 v[126:127], v[116:117], v[74:75]
    v_pk_mul_f32 v[146:147], v[136:137], v[90:91]
    v_exp_f32 v114, v114
    v_exp_f32 v115, v115
    v_exp_f32 v134, v134
    v_exp_f32 v135, v135
    v_pk_mul_f32 v[108:109], v[68:69], v[120:121]
    v_pk_mul_f32 v[128:129], v[84:85], v[140:141]
    v_pk_mul_f32 v[110:111], v[68:69], v[122:123]
    v_pk_mul_f32 v[130:131], v[84:85], v[142:143]
    v_pk_fma_f32 v[124:125], v[118:119], v[74:75], v[124:125] neg_lo:[1,0,0] neg_hi:[1,0,0]
    v_pk_fma_f32 v[144:145], v[138:139], v[90:91], v[144:145] neg_lo:[1,0,0] neg_hi:[1,0,0]
    v_pk_fma_f32 v[126:127], v[118:119], v[72:73], v[126:127]
    v_pk_fma_f32 v[146:147], v[138:139], v[88:89], v[146:147]
    v_pk_fma_f32 v[108:109], v[70:71], v[122:123], v[108:109] neg_lo:[1,0,0] neg_hi:[1,0,0]
    v_pk_fma_f32 v[128:129], v[86:87], v[142:143], v[128:129] neg_lo:[1,0,0] neg_hi:[1,0,0]
    v_pk_fma_f32 v[110:111], v[70:71], v[120:121], v[110:111]
    v_pk_fma_f32 v[130:131], v[86:87], v[140:141], v[130:131]
    v_cvt_pk_f16_f32 v104, v116, v118
    v_cvt_pk_f16_f32 v105, v117, v119
    v_cvt_pk_f16_f32 v106, v136, v138
    v_cvt_pk_f16_f32 v107, v137, v139
    v_pk_mul_f32 v[108:109], v[114:115], v[108:109]
    v_pk_mul_f32 v[128:129], v[134:135], v[128:129]
    v_pk_mul_f32 v[110:111], v[114:115], v[110:111]
    v_pk_mul_f32 v[130:131], v[134:135], v[130:131]
    v_cvt_pk_f16_f32 v196, v124, v126
    v_cvt_pk_f16_f32 v197, v125, v127
    v_cvt_pk_f16_f32 v198, v144, v146
    v_cvt_pk_f16_f32 v199, v145, v147
    v_pk_mul_f32 v[120:121], v[108:109], v[76:77]
    v_pk_mul_f32 v[140:141], v[128:129], v[92:93]
    v_pk_mul_f32 v[122:123], v[108:109], v[78:79]
    v_pk_mul_f32 v[142:143], v[128:129], v[94:95]
    v_cvt_pk_f16_f32 v96, v108, -v110
    v_cvt_pk_f16_f32 v97, v109, -v111
    v_cvt_pk_f16_f32 v98, v128, -v130
    v_cvt_pk_f16_f32 v99, v129, -v131
    v_pk_fma_f32 v[120:121], v[110:111], v[78:79], v[120:121] neg_lo:[1,0,0] neg_hi:[1,0,0]
    v_pk_fma_f32 v[140:141], v[130:131], v[94:95], v[140:141] neg_lo:[1,0,0] neg_hi:[1,0,0]
    v_pk_fma_f32 v[122:123], v[110:111], v[76:77], v[122:123]
    v_pk_fma_f32 v[142:143], v[130:131], v[92:93], v[142:143]
    v_mfma_f32_16x16x32_f16 v[148:151], v[96:99], v[104:107], v[148:151]
    v_mfma_f32_16x16x32_f16 v[152:155], v[96:99], v[196:199], v[152:155]
    v_cvt_pk_f16_f32 v100, v120, -v122
    v_cvt_pk_f16_f32 v101, v121, -v123
    v_cvt_pk_f16_f32 v102, v140, -v142
    v_cvt_pk_f16_f32 v103, v141, -v143
    s_nop 1
    v_mfma_f32_16x16x32_f16 v[156:159], v[100:103], v[104:107], v[156:159]
    v_mfma_f32_16x16x32_f16 v[160:163], v[100:103], v[196:199], v[160:163]
    s_waitcnt lgkmcnt(0)
    v_add_u32 v7, 0x100, v7
    ds_read_b128 v[64:67], v7 offset:0
    ds_read_b128 v[68:71], v7 offset:2048
    ds_read_b128 v[72:75], v7 offset:4096
    ds_read_b128 v[76:79], v7 offset:6144
    ds_read_b128 v[80:83], v7 offset:16
    ds_read_b128 v[84:87], v7 offset:2064
    ds_read_b128 v[88:91], v7 offset:4112
    ds_read_b128 v[92:95], v7 offset:6160
    v_pk_mul_f32 v[110:111], v[166:167], v[34:35]
    v_pk_mul_f32 v[130:131], v[182:183], v[34:35]
    v_pk_mul_f32 v[108:109], v[166:167], v[32:33]
    v_pk_mul_f32 v[128:129], v[182:183], v[32:33]
    v_pk_fma_f32 v[112:113], v[164:165], v[32:33], v[36:37]
    v_pk_fma_f32 v[132:133], v[180:181], v[32:33], v[36:37]
    v_pk_mul_f32 v[114:115], v[164:165], v[34:35]
    v_pk_mul_f32 v[134:135], v[180:181], v[34:35]
    v_fract_f32 v110, v110
    v_fract_f32 v111, v111
    v_fract_f32 v130, v130
    v_fract_f32 v131, v131
    v_exp_f32 v112, v112
    v_exp_f32 v113, v113
    v_exp_f32 v132, v132
    v_exp_f32 v133, v133
    v_cos_f32 v116, v108
    v_cos_f32 v117, v109
    v_cos_f32 v136, v128
    v_cos_f32 v137, v129
    v_sin_f32 v118, v108
    v_sin_f32 v119, v109
    v_sin_f32 v138, v128
    v_sin_f32 v139, v129
    v_cos_f32 v120, v110
    v_cos_f32 v121, v111
    v_cos_f32 v140, v130
    v_cos_f32 v141, v131
    v_pk_mul_f32 v[116:117], v[112:113], v[116:117]
    v_pk_mul_f32 v[136:137], v[132:133], v[136:137]
    v_pk_mul_f32 v[118:119], v[112:113], v[118:119]
    v_pk_mul_f32 v[138:139], v[132:133], v[138:139]
    v_sin_f32 v122, v110
    v_sin_f32 v123, v111
    v_sin_f32 v142, v130
    v_sin_f32 v143, v131
    v_pk_mul_f32 v[124:125], v[116:117], v[172:173]
    v_pk_mul_f32 v[144:145], v[136:137], v[188:189]
    v_pk_mul_f32 v[126:127], v[116:117], v[174:175]
    v_pk_mul_f32 v[146:147], v[136:137], v[190:191]
    v_exp_f32 v114, v114
    v_exp_f32 v115, v115
    v_exp_f32 v134, v134
    v_exp_f32 v135, v135
    v_pk_mul_f32 v[108:109], v[168:169], v[120:121]
    v_pk_mul_f32 v[128:129], v[184:185], v[140:141]
    v_pk_mul_f32 v[110:111], v[168:169], v[122:123]
    v_pk_mul_f32 v[130:131], v[184:185], v[142:143]
    v_pk_fma_f32 v[124:125], v[118:119], v[174:175], v[124:125] neg_lo:[1,0,0] neg_hi:[1,0,0]
    v_pk_fma_f32 v[144:145], v[138:139], v[190:191], v[144:145] neg_lo:[1,0,0] neg_hi:[1,0,0]
    v_pk_fma_f32 v[126:127], v[118:119], v[172:173], v[126:127]
    v_pk_fma_f32 v[146:147], v[138:139], v[188:189], v[146:147]
    v_pk_fma_f32 v[108:109], v[170:171], v[122:123], v[108:109] neg_lo:[1,0,0] neg_hi:[1,0,0]
    v_pk_fma_f32 v[128:129], v[186:187], v[142:143], v[128:129] neg_lo:[1,0,0] neg_hi:[1,0,0]
    v_pk_fma_f32 v[110:111], v[170:171], v[120:121], v[110:111]
    v_pk_fma_f32 v[130:131], v[186:187], v[140:141], v[130:131]
    v_cvt_pk_f16_f32 v104, v116, v118
    v_cvt_pk_f16_f32 v105, v117, v119
    v_cvt_pk_f16_f32 v106, v136, v138
    v_cvt_pk_f16_f32 v107, v137, v139
    v_pk_mul_f32 v[108:109], v[114:115], v[108:109]
    v_pk_mul_f32 v[128:129], v[134:135], v[128:129]
    v_pk_mul_f32 v[110:111], v[114:115], v[110:111]
    v_pk_mul_f32 v[130:131], v[134:135], v[130:131]
    v_cvt_pk_f16_f32 v196, v124, v126
    v_cvt_pk_f16_f32 v197, v125, v127
    v_cvt_pk_f16_f32 v198, v144, v146
    v_cvt_pk_f16_f32 v199, v145, v147
    v_pk_mul_f32 v[120:121], v[108:109], v[176:177]
    v_pk_mul_f32 v[140:141], v[128:129], v[192:193]
    v_pk_mul_f32 v[122:123], v[108:109], v[178:179]
    v_pk_mul_f32 v[142:143], v[128:129], v[194:195]
    v_cvt_pk_f16_f32 v96, v108, -v110
    v_cvt_pk_f16_f32 v97, v109, -v111
    v_cvt_pk_f16_f32 v98, v128, -v130
    v_cvt_pk_f16_f32 v99, v129, -v131
    v_pk_fma_f32 v[120:121], v[110:111], v[178:179], v[120:121] neg_lo:[1,0,0] neg_hi:[1,0,0]
    v_pk_fma_f32 v[140:141], v[130:131], v[194:195], v[140:141] neg_lo:[1,0,0] neg_hi:[1,0,0]
    v_pk_fma_f32 v[122:123], v[110:111], v[176:177], v[122:123]
    v_pk_fma_f32 v[142:143], v[130:131], v[192:193], v[142:143]
    v_mfma_f32_16x16x32_f16 v[148:151], v[96:99], v[104:107], v[148:151]
    v_mfma_f32_16x16x32_f16 v[152:155], v[96:99], v[196:199], v[152:155]
    v_cvt_pk_f16_f32 v100, v120, -v122
    v_cvt_pk_f16_f32 v101, v121, -v123
    v_cvt_pk_f16_f32 v102, v140, -v142
    v_cvt_pk_f16_f32 v103, v141, -v143
    s_add_u32 s51, s51, 1
    s_cmp_lt_u32 s51, 2
    v_mfma_f32_16x16x32_f16 v[156:159], v[100:103], v[104:107], v[156:159]
    v_mfma_f32_16x16x32_f16 v[160:163], v[100:103], v[196:199], v[160:163]
    s_cbranch_scc1 Lkgen
    v_and_b32 v43, 0x7f, v0
    v_lshlrev_b32 v43, 2, v43
    s_mul_i32 s94, s42, 16896
    s_add_u32 s94, s94, 64
    v_add_u32 v44, s94, v43
    v_add_u32 v45, 4220, v44
    v_lshl_add_u32 v43, v43, 1, s45
    s_lshl_b32 s95, s3, 11
    s_add_u32 s95, s95, 90880
    v_add_u32 v41, s95, v40
    s_xor_b32 s95, s3, 1
    s_lshl_b32 s95, s95, 11
    s_add_u32 s95, s95, 90880
    v_add_u32 v42, s95, v40
    s_waitcnt lgkmcnt(0)
    v_cndmask_b32 v64, v148, v156, s[92:93]
    v_cndmask_b32 v65, v149, v157, s[92:93]
    v_cndmask_b32 v66, v150, v158, s[92:93]
    v_cndmask_b32 v67, v151, v159, s[92:93]
    v_cndmask_b32 v68, v152, v160, s[92:93]
    v_cndmask_b32 v69, v153, v161, s[92:93]
    v_cndmask_b32 v70, v154, v162, s[92:93]
    v_cndmask_b32 v71, v155, v163, s[92:93]
    v_mul_f32 v64, v9, v64
    v_mul_f32 v65, v9, v65
    v_mul_f32 v66, v9, v66
    v_mul_f32 v67, v9, v67
    v_mul_f32 v68, v9, v68
    v_mul_f32 v69, v9, v69
    v_mul_f32 v70, v9, v70
    v_mul_f32 v71, v9, v71
    ds_write_b128 v41, v[64:67]
    ds_write_b128 v41, v[68:71] offset:1024
    ds_write_b32 v26, v28 offset:208
    v_cndmask_b32 v72, v156, v148, s[92:93]
    v_cndmask_b32 v73, v157, v149, s[92:93]
    v_cndmask_b32 v74, v158, v150, s[92:93]
    v_cndmask_b32 v75, v159, v151, s[92:93]
    v_cndmask_b32 v76, v160, v152, s[92:93]
    v_cndmask_b32 v77, v161, v153, s[92:93]
    v_cndmask_b32 v78, v162, v154, s[92:93]
    v_cndmask_b32 v79, v163, v155, s[92:93]
    s_nop 4
Lsy1:
    ds_read_b64 v[30:31], v27 offset:208
    s_waitcnt lgkmcnt(0)
    v_and_b32 v30, v30, v31
    v_cmp_ne_u32 vcc, 0, v30
    s_cbranch_vccz Lsy1
    ds_read_b128 v[64:67], v42
    ds_read_b128 v[68:71], v42 offset:1024
    s_waitcnt lgkmcnt(1)
    v_fma_f32 v72, v72, v9, v64
    ds_write_b32 v200, v72
    v_fma_f32 v73, v73, v9, v65
    ds_write_b32 v201, v73
    v_fma_f32 v74, v74, v9, v66
    ds_write_b32 v202, v74
    v_fma_f32 v75, v75, v9, v67
    ds_write_b32 v203, v75
    s_waitcnt lgkmcnt(4)
    s_nop 0
    v_fma_f32 v76, v76, v9, v68
    ds_write_b32 v204, v76
    v_fma_f32 v77, v77, v9, v69
    ds_write_b32 v205, v77
    v_fma_f32 v78, v78, v9, v70
    ds_write_b32 v206, v78
    v_fma_f32 v79, v79, v9, v71
    ds_write_b32 v207, v79
    ds_write_b32 v26, v28 offset:224
    s_nop 2
Lsy2:
    ds_read_b64 v[30:31], v27 offset:224
    s_waitcnt lgkmcnt(0)
    v_and_b32 v30, v30, v31
    v_cmp_ne_u32 vcc, 0, v30
    s_cbranch_vccz Lsy2
    s_nop 0
    ds_read_b64 v[64:65], v43
    ds_read_b32 v66, v20 offset:0
    ds_read_b32 v67, v21 offset:0
    ds_read_b32 v68, v22 offset:0
    ds_read_b32 v69, v23 offset:0
    ds_read_b32 v70, v22 offset:256
    ds_read_b32 v71, v23 offset:256
    ds_read_b32 v72, v24 offset:0
    ds_read_b32 v73, v25 offset:0
    ds_read_b32 v74, v24 offset:128
    ds_read_b32 v75, v25 offset:128
    ds_read_b32 v76, v24 offset:256
    ds_read_b32 v77, v25 offset:256
    ds_read_b32 v78, v24 offset:384
    ds_read_b32 v79, v25 offset:384
    s_waitcnt lgkmcnt(8)
    s_nop 0
    v_cvt_pk_bf16_f32 v80, v64, v65
    v_cvt_pk_bf16_f32 v81, v66, v67
    v_cvt_pk_bf16_f32 v82, v68, v69
    v_cvt_pk_bf16_f32 v83, v70, v71
    s_waitcnt lgkmcnt(0)
    s_waitcnt lgkmcnt(0)
    v_cvt_pk_bf16_f32 v84, v72, v73
    v_cvt_pk_bf16_f32 v85, v74, v75
    v_cvt_pk_bf16_f32 v86, v76, v77
    v_cvt_pk_bf16_f32 v87, v78, v79
    ds_write_b32 v44, v80 offset:0
    ds_write_b32 v45, v80 offset:0
    ds_write_b32 v44, v81 offset:512
    ds_write_b32 v45, v81 offset:512
    ds_write_b32 v44, v82 offset:1024
    ds_write_b32 v45, v82 offset:1024
    ds_write_b32 v44, v83 offset:1536
    ds_write_b32 v45, v83 offset:1536
    ds_write_b32 v44, v84 offset:2048
    ds_write_b32 v45, v84 offset:2048
    ds_write_b32 v44, v85 offset:2560
    ds_write_b32 v45, v85 offset:2560
    s_waitcnt lgkmcnt(4)
    s_nop 0
    ds_write_b32 v44, v86 offset:3072
    ds_write_b32 v45, v86 offset:3072
    ds_write_b32 v44, v87 offset:3584
    ds_write_b32 v45, v87 offset:3584
    ds_write_b32 v26, v28 offset:240
Lsy3:
    ds_read_b64 v[30:31], v27 offset:240
    s_waitcnt lgkmcnt(0)
    v_and_b32 v30, v30, v31
    v_cmp_ne_u32 vcc, 0, v30
    s_cbranch_vccz Lsy3
    s_nop 3
Lsy4:
    ds_read_b64 v[30:31], v27 offset:256
    s_waitcnt lgkmcnt(0)
    v_and_b32 v30, v30, v31
    v_cmp_ne_u32 vcc, 0, v30
    s_cbranch_vccz Lsy4
    s_mul_i32 s94, s3, 8448
    s_add_u32 s94, s94, 0
    v_lshl_add_u32 v4, v3, 2, v2
    v_lshlrev_b32 v4, 2, v4
    v_and_b32 v44, 1, v2
    v_mov_b32 v45, 4224
    v_cmp_eq_u32 vcc, 1, v44
    s_nop 1
    v_cndmask_b32 v45, v45, 4, vcc
    v_add3_u32 v4, v4, v45, s94
    v_mul_u32_u24 v5, 4576, v44
    v_lshrrev_b32 v44, 1, v2
    v_lshlrev_b32 v44, 6, v44
    v_sub_u32_e64 v5, v5, v44
    v_lshl_add_u32 v5, v3, 4, v5
    s_mul_i32 s94, s3, 9152
    s_add_u32 s94, s94, 34240
    v_add_u32 v5, s94, v5
    s_lshl_b32 s94, s3, 12
    s_add_u32 s94, s94, 70400
    v_lshlrev_b32_e64 v6, 2, v2
    v_lshl_add_u32 v6, v3, 7, v6
    v_add_u32 v6, s94, v6
    v_mov_b32 v7, v26
    v_mov_b32_e64 v1, 1
    v_add_u32 v2, 128, v26
    s_setprio 2
    s_nop 0
    ds_read_b64 v[76:77], v4 offset:0
    ds_read_b64 v[78:79], v4 offset:8
    ds_read_b64 v[80:81], v4 offset:64
    ds_read_b64 v[82:83], v4 offset:72
    ds_read_b64 v[84:85], v4 offset:128
    ds_read_b64 v[86:87], v4 offset:136
    ds_read_b64 v[88:89], v4 offset:192
    ds_read_b64 v[90:91], v4 offset:200
    ds_read_b64 v[92:93], v4 offset:256
    ds_read_b64 v[94:95], v4 offset:264
    ds_read_b64 v[96:97], v4 offset:320
    ds_read_b64 v[98:99], v4 offset:328
    s_waitcnt lgkmcnt(8)
    s_nop 0
    ds_read_b64 v[100:101], v4 offset:384
    ds_read_b64 v[102:103], v4 offset:392
    ds_read_b64 v[104:105], v4 offset:448
    ds_read_b64 v[106:107], v4 offset:456
    ds_read_b64 v[108:109], v4 offset:512
    ds_read_b64 v[110:111], v4 offset:520
    s_waitcnt lgkmcnt(8)
    s_nop 0
    ds_read_b64 v[112:113], v4 offset:576
    ds_read_b64 v[114:115], v4 offset:584
    ds_read_b64 v[116:117], v4 offset:640
    ds_read_b64 v[118:119], v4 offset:648
    ds_read_b64 v[120:121], v4 offset:704
    ds_read_b64 v[122:123], v4 offset:712
    s_waitcnt lgkmcnt(8)
    s_nop 0
    ds_read_b64 v[124:125], v4 offset:768
    ds_read_b64 v[126:127], v4 offset:776
    ds_read_b64 v[128:129], v4 offset:832
    ds_read_b64 v[130:131], v4 offset:840
    ds_read_b64 v[132:133], v4 offset:896
    ds_read_b64 v[134:135], v4 offset:904
    s_waitcnt lgkmcnt(8)
    s_nop 0
    ds_read_b64 v[136:137], v4 offset:960
    ds_read_b64 v[138:139], v4 offset:968
    ds_read_b64 v[140:141], v4 offset:1024
    ds_read_b64 v[142:143], v4 offset:1032
    ds_read_b64 v[144:145], v4 offset:1088
    ds_read_b64 v[146:147], v4 offset:1096
    s_waitcnt lgkmcnt(8)
    s_nop 0
    ds_read_b64 v[148:149], v4 offset:1152
    ds_read_b64 v[150:151], v4 offset:1160
    ds_read_b64 v[152:153], v4 offset:1216
    ds_read_b64 v[154:155], v4 offset:1224
Lug0:
    ds_read_b32 v252, v2 offset:0
    s_waitcnt lgkmcnt(0)
    v_cmp_ne_u32 vcc, 0, v252
    s_cbranch_vccz Lug0
    ds_read_b128 v[28:31], v5 offset:3072
    ds_read_b128 v[32:35], v5 offset:3584
    s_waitcnt lgkmcnt(1)
    v_mfma_f32_16x16x32_bf16 v[12:15], v[28:31], v[76:79], 0
    ds_read_b128 v[36:39], v5 offset:3136
    ds_read_b128 v[40:43], v5 offset:3648
    s_waitcnt lgkmcnt(2)
    s_nop 0
    v_mfma_f32_16x16x32_bf16 v[12:15], v[32:35], v[108:111], v[12:15]
    ds_read_b128 v[44:47], v5 offset:3200
    ds_read_b128 v[48:51], v5 offset:3712
    v_mfma_f32_16x16x32_bf16 v[8:11], v[32:35], v[76:79], 0
    ds_read_b128 v[52:55], v5 offset:3264
    ds_read_b128 v[56:59], v5 offset:3776
    s_waitcnt lgkmcnt(5)
    s_nop 0
    v_mfma_f32_16x16x32_bf16 v[12:15], v[36:39], v[80:83], v[12:15]
    ds_read_b32 v252, v2 offset:16
    ds_read_b128 v[28:31], v5 offset:3328
    ds_read_b128 v[32:35], v5 offset:3840
    s_waitcnt lgkmcnt(7)
    s_nop 0
    v_mfma_f32_16x16x32_bf16 v[12:15], v[40:43], v[112:115], v[12:15]
    ds_read_b128 v[36:39], v5 offset:3392
    v_mfma_f32_16x16x32_bf16 v[8:11], v[40:43], v[80:83], v[8:11]
    ds_read_b128 v[40:43], v5 offset:3904
    s_waitcnt lgkmcnt(8)
    v_mfma_f32_16x16x32_bf16 v[12:15], v[44:47], v[84:87], v[12:15]
    ds_read_b128 v[44:47], v5 offset:3456
    s_waitcnt lgkmcnt(8)
    v_mfma_f32_16x16x32_bf16 v[12:15], v[48:51], v[116:119], v[12:15]
    ds_read_b64 v[172:173], v4 offset:1536
    ds_read_b64 v[174:175], v4 offset:1544
    v_mfma_f32_16x16x32_bf16 v[8:11], v[48:51], v[84:87], v[8:11]
    ds_read_b128 v[48:51], v5 offset:3968
    s_waitcnt lgkmcnt(10)
    v_mfma_f32_16x16x32_bf16 v[12:15], v[52:55], v[88:91], v[12:15]
    ds_read_b128 v[52:55], v5 offset:3520
    s_waitcnt lgkmcnt(10)
    v_mfma_f32_16x16x32_bf16 v[12:15], v[56:59], v[120:123], v[12:15]
    v_mfma_f32_16x16x32_bf16 v[8:11], v[56:59], v[88:91], v[8:11]
    ds_read_b128 v[56:59], v5 offset:4032
    s_waitcnt lgkmcnt(9)
    v_mfma_f32_16x16x32_bf16 v[12:15], v[28:31], v[92:95], v[12:15]
    v_cmp_ne_u32 vcc, 0, v252
    s_cbranch_vccnz Lugd1
Lug1:
    ds_read_b32 v252, v2 offset:16
    s_waitcnt lgkmcnt(0)
    v_cmp_ne_u32 vcc, 0, v252
    s_cbranch_vccz Lug1
Lugd1:
    ds_read_b128 v[28:31], v5 offset:2048
    s_waitcnt lgkmcnt(9)
    s_nop 0
    v_mfma_f32_16x16x32_bf16 v[12:15], v[32:35], v[124:127], v[12:15]
    ds_read_b64 v[176:177], v4 offset:1600
    ds_read_b64 v[178:179], v4 offset:1608
    v_mfma_f32_16x16x32_bf16 v[8:11], v[32:35], v[92:95], v[8:11]
    ds_read_b128 v[32:35], v5 offset:2560
    s_waitcnt lgkmcnt(11)
    v_mfma_f32_16x16x32_bf16 v[12:15], v[36:39], v[96:99], v[12:15]
    ds_read_b128 v[36:39], v5 offset:3072
    s_waitcnt lgkmcnt(11)
    v_mfma_f32_16x16x32_bf16 v[12:15], v[40:43], v[128:131], v[12:15]
    v_mfma_f32_16x16x32_bf16 v[8:11], v[40:43], v[96:99], v[8:11]
    ds_read_b128 v[40:43], v5 offset:3584
    s_waitcnt lgkmcnt(11)
    v_mfma_f32_16x16x32_bf16 v[12:15], v[44:47], v[100:103], v[12:15]
    ds_read_b128 v[44:47], v5 offset:2112
    s_waitcnt lgkmcnt(9)
    v_mfma_f32_16x16x32_bf16 v[12:15], v[48:51], v[132:135], v[12:15]
    ds_read_b64 v[180:181], v4 offset:1664
    ds_read_b64 v[182:183], v4 offset:1672
    v_mfma_f32_16x16x32_bf16 v[8:11], v[48:51], v[100:103], v[8:11]
    ds_read_b128 v[48:51], v5 offset:2624
    s_waitcnt lgkmcnt(11)
    v_mfma_f32_16x16x32_bf16 v[12:15], v[52:55], v[104:107], v[12:15]
    ds_read_b128 v[52:55], v5 offset:3136
    s_waitcnt lgkmcnt(11)
    v_mfma_f32_16x16x32_bf16 v[12:15], v[56:59], v[136:139], v[12:15]
    v_mfma_f32_16x16x32_bf16 v[8:11], v[56:59], v[104:107], v[8:11]
    ds_read_b128 v[56:59], v5 offset:3648
    s_waitcnt lgkmcnt(11)
    v_mfma_f32_16x16x32_bf16 v[20:23], v[28:31], v[76:79], 0
    ds_read_b128 v[28:31], v5 offset:2176
    s_waitcnt lgkmcnt(9)
    v_mfma_f32_16x16x32_bf16 v[20:23], v[32:35], v[108:111], v[20:23]
    ds_read_b64 v[184:185], v4 offset:1728
    ds_read_b64 v[186:187], v4 offset:1736
    v_mfma_f32_16x16x32_bf16 v[16:19], v[32:35], v[76:79], 0
    s_waitcnt lgkmcnt(8)
    s_nop 0
    v_cvt_pk_bf16_f32 v24, v8, v9
    v_cvt_pk_bf16_f32 v25, v10, v11
    ds_write2_b32 v6, v24, v25 offset0:0 offset1:16
    ds_write_b32 v7, v1 offset:0
    v_cvt_pk_bf16_f32 v26, v12, v13
    v_cvt_pk_bf16_f32 v27, v14, v15
    ds_write2_b32 v6, v26, v27 offset0:128 offset1:144
    ds_write_b32 v7, v1 offset:16
    v_add_u32 v6, 0x400, v6
    v_mfma_f32_16x16x32_bf16 v[20:23], v[36:39], v[140:143], v[20:23]
    v_mfma_f32_16x16x32_bf16 v[16:19], v[36:39], v[108:111], v[16:19]
    v_mfma_f32_16x16x32_bf16 v[20:23], v[40:43], v[172:175], v[20:23]
    v_mfma_f32_16x16x32_bf16 v[16:19], v[40:43], v[140:143], v[16:19]
    v_mfma_f32_16x16x32_bf16 v[20:23], v[44:47], v[80:83], v[20:23]
    s_waitcnt lgkmcnt(9)
    s_nop 0
    v_mfma_f32_16x16x32_bf16 v[20:23], v[48:51], v[112:115], v[20:23]
    ds_read_b128 v[32:35], v5 offset:2688
    ds_read_b128 v[36:39], v5 offset:3200
    v_mfma_f32_16x16x32_bf16 v[16:19], v[48:51], v[80:83], v[16:19]
    ds_read_b128 v[40:43], v5 offset:3712
    s_waitcnt lgkmcnt(11)
    v_mfma_f32_16x16x32_bf16 v[20:23], v[52:55], v[144:147], v[20:23]
    ds_read_b128 v[44:47], v5 offset:2240
    v_mfma_f32_16x16x32_bf16 v[16:19], v[52:55], v[112:115], v[16:19]
    s_waitcnt lgkmcnt(11)
    v_mfma_f32_16x16x32_bf16 v[20:23], v[56:59], v[176:179], v[20:23]
    ds_read_b128 v[48:51], v5 offset:2752
    v_mfma_f32_16x16x32_bf16 v[16:19], v[56:59], v[144:147], v[16:19]
    s_waitcnt lgkmcnt(11)
    v_mfma_f32_16x16x32_bf16 v[20:23], v[28:31], v[84:87], v[20:23]
    ds_read_b128 v[52:55], v5 offset:3264
    s_waitcnt lgkmcnt(5)
    v_mfma_f32_16x16x32_bf16 v[20:23], v[32:35], v[116:119], v[20:23]
    ds_read_b128 v[56:59], v5 offset:3776
    ds_read_b128 v[28:31], v5 offset:2304
    v_mfma_f32_16x16x32_bf16 v[16:19], v[32:35], v[84:87], v[16:19]
    ds_read_b128 v[32:35], v5 offset:2816
    s_waitcnt lgkmcnt(7)
    s_nop 0
    v_mfma_f32_16x16x32_bf16 v[20:23], v[36:39], v[148:151], v[20:23]
    ds_read_b64 v[156:157], v4 offset:1280
    ds_read_b64 v[158:159], v4 offset:1288
    v_mfma_f32_16x16x32_bf16 v[16:19], v[36:39], v[116:119], v[16:19]
    ds_read_b128 v[36:39], v5 offset:3328
    s_waitcnt lgkmcnt(9)
    s_nop 0
    v_mfma_f32_16x16x32_bf16 v[20:23], v[40:43], v[180:183], v[20:23]
    ds_read_b64 v[188:189], v4 offset:1792
    ds_read_b64 v[190:191], v4 offset:1800
    v_mfma_f32_16x16x32_bf16 v[16:19], v[40:43], v[148:151], v[16:19]
    ds_read_b128 v[40:43], v5 offset:3840
    s_waitcnt lgkmcnt(11)
    v_mfma_f32_16x16x32_bf16 v[20:23], v[44:47], v[88:91], v[20:23]
    ds_read_b128 v[44:47], v5 offset:2368
    s_waitcnt lgkmcnt(11)
    v_mfma_f32_16x16x32_bf16 v[20:23], v[48:51], v[120:123], v[20:23]
    v_mfma_f32_16x16x32_bf16 v[16:19], v[48:51], v[88:91], v[16:19]
    ds_read_b128 v[48:51], v5 offset:2880
    s_waitcnt lgkmcnt(11)
    v_mfma_f32_16x16x32_bf16 v[20:23], v[52:55], v[152:155], v[20:23]
    v_mfma_f32_16x16x32_bf16 v[16:19], v[52:55], v[120:123], v[16:19]
    ds_read_b128 v[52:55], v5 offset:3392
    s_waitcnt lgkmcnt(11)
    v_mfma_f32_16x16x32_bf16 v[20:23], v[56:59], v[184:187], v[20:23]
    v_mfma_f32_16x16x32_bf16 v[16:19], v[56:59], v[152:155], v[16:19]
    ds_read_b128 v[56:59], v5 offset:3904
    s_waitcnt lgkmcnt(11)
    v_mfma_f32_16x16x32_bf16 v[20:23], v[28:31], v[92:95], v[20:23]
    ds_read_b128 v[28:31], v5 offset:2432
    s_waitcnt lgkmcnt(11)
    v_mfma_f32_16x16x32_bf16 v[20:23], v[32:35], v[124:127], v[20:23]
    v_mfma_f32_16x16x32_bf16 v[16:19], v[32:35], v[92:95], v[16:19]
    ds_read_b128 v[32:35], v5 offset:2944
    s_waitcnt lgkmcnt(9)
    s_nop 0
    v_mfma_f32_16x16x32_bf16 v[20:23], v[36:39], v[156:159], v[20:23]
    ds_read_b64 v[160:161], v4 offset:1344
    ds_read_b64 v[162:163], v4 offset:1352
    v_mfma_f32_16x16x32_bf16 v[16:19], v[36:39], v[124:127], v[16:19]
    ds_read_b128 v[36:39], v5 offset:3456
    s_waitcnt lgkmcnt(9)
    s_nop 0
    v_mfma_f32_16x16x32_bf16 v[20:23], v[40:43], v[188:191], v[20:23]
    ds_read_b64 v[192:193], v4 offset:1856
    ds_read_b64 v[194:195], v4 offset:1864
    v_mfma_f32_16x16x32_bf16 v[16:19], v[40:43], v[156:159], v[16:19]
    ds_read_b128 v[40:43], v5 offset:3968
    s_waitcnt lgkmcnt(11)
    v_mfma_f32_16x16x32_bf16 v[20:23], v[44:47], v[96:99], v[20:23]
    ds_read_b32 v252, v2 offset:32
    s_waitcnt lgkmcnt(11)
    v_mfma_f32_16x16x32_bf16 v[20:23], v[48:51], v[128:131], v[20:23]
    ds_read_b128 v[44:47], v5 offset:2496
    v_mfma_f32_16x16x32_bf16 v[16:19], v[48:51], v[96:99], v[16:19]
    s_waitcnt lgkmcnt(6)
    s_nop 0
    v_mfma_f32_16x16x32_bf16 v[20:23], v[52:55], v[160:163], v[20:23]
    ds_read_b128 v[48:51], v5 offset:3008
    ds_read_b64 v[164:165], v4 offset:1408
    ds_read_b64 v[166:167], v4 offset:1416
    v_mfma_f32_16x16x32_bf16 v[16:19], v[52:55], v[128:131], v[16:19]
    ds_read_b128 v[52:55], v5 offset:3520
    s_waitcnt lgkmcnt(7)
    s_nop 0
    v_mfma_f32_16x16x32_bf16 v[20:23], v[56:59], v[192:195], v[20:23]
    ds_read_b64 v[196:197], v4 offset:1920
    ds_read_b64 v[198:199], v4 offset:1928
    v_mfma_f32_16x16x32_bf16 v[16:19], v[56:59], v[160:163], v[16:19]
    ds_read_b128 v[56:59], v5 offset:4032
    v_mfma_f32_16x16x32_bf16 v[20:23], v[28:31], v[100:103], v[20:23]
    s_waitcnt lgkmcnt(8)
    v_cmp_ne_u32 vcc, 0, v252
    s_cbranch_vccnz Lugd2
Lug2:
    ds_read_b32 v252, v2 offset:32
    s_waitcnt lgkmcnt(0)
    v_cmp_ne_u32 vcc, 0, v252
    s_cbranch_vccz Lug2
Lugd2:
    ds_read_b128 v[28:31], v5 offset:1024
    v_mfma_f32_16x16x32_bf16 v[20:23], v[32:35], v[132:135], v[20:23]
    ds_read_b64 v[168:169], v4 offset:1472
    ds_read_b64 v[170:171], v4 offset:1480
    v_mfma_f32_16x16x32_bf16 v[16:19], v[32:35], v[100:103], v[16:19]
    ds_read_b128 v[32:35], v5 offset:1536
    s_waitcnt lgkmcnt(8)
    s_nop 0
    v_mfma_f32_16x16x32_bf16 v[20:23], v[36:39], v[164:167], v[20:23]
    ds_read_b64 v[200:201], v4 offset:1984
    ds_read_b64 v[202:203], v4 offset:1992
    v_mfma_f32_16x16x32_bf16 v[16:19], v[36:39], v[132:135], v[16:19]
    ds_read_b128 v[36:39], v5 offset:2048
    s_waitcnt lgkmcnt(8)
    s_nop 0
    v_mfma_f32_16x16x32_bf16 v[20:23], v[40:43], v[196:199], v[20:23]
    ds_read_b64 v[204:205], v4 offset:2048
    ds_read_b64 v[206:207], v4 offset:2056
    v_mfma_f32_16x16x32_bf16 v[16:19], v[40:43], v[164:167], v[16:19]
    ds_read_b128 v[40:43], v5 offset:2560
    v_mfma_f32_16x16x32_bf16 v[20:23], v[44:47], v[104:107], v[20:23]
    ds_read_b128 v[44:47], v5 offset:3072
    v_mfma_f32_16x16x32_bf16 v[20:23], v[48:51], v[136:139], v[20:23]
    v_mfma_f32_16x16x32_bf16 v[16:19], v[48:51], v[104:107], v[16:19]
    s_waitcnt lgkmcnt(8)
    s_nop 0
    v_mfma_f32_16x16x32_bf16 v[20:23], v[52:55], v[168:171], v[20:23]
    ds_read_b128 v[48:51], v5 offset:3584
    v_mfma_f32_16x16x32_bf16 v[16:19], v[52:55], v[136:139], v[16:19]
    ds_read_b128 v[52:55], v5 offset:1088
    s_waitcnt lgkmcnt(7)
    s_nop 0
    v_mfma_f32_16x16x32_bf16 v[20:23], v[56:59], v[200:203], v[20:23]
    ds_read_b64 v[236:237], v4 offset:2560
    ds_read_b64 v[238:239], v4 offset:2568
    v_mfma_f32_16x16x32_bf16 v[16:19], v[56:59], v[168:171], v[16:19]
    ds_read_b128 v[56:59], v5 offset:1600
    v_mfma_f32_16x16x32_bf16 v[12:15], v[28:31], v[76:79], 0
    ds_read_b128 v[28:31], v5 offset:2112
    v_mfma_f32_16x16x32_bf16 v[12:15], v[32:35], v[108:111], v[12:15]
    v_mfma_f32_16x16x32_bf16 v[8:11], v[32:35], v[76:79], 0
    s_waitcnt lgkmcnt(8)
    s_nop 1
    v_cvt_pk_bf16_f32 v24, v16, v17
    v_cvt_pk_bf16_f32 v25, v18, v19
    ds_write2_b32 v6, v24, v25 offset0:0 offset1:16
    ds_write_b32 v7, v1 offset:32
    v_cvt_pk_bf16_f32 v26, v20, v21
    v_cvt_pk_bf16_f32 v27, v22, v23
    ds_write2_b32 v6, v26, v27 offset0:128 offset1:144
    ds_write_b32 v7, v1 offset:48
    v_add_u32 v6, 0x400, v6
    v_mfma_f32_16x16x32_bf16 v[12:15], v[36:39], v[140:143], v[12:15]
    v_mfma_f32_16x16x32_bf16 v[8:11], v[36:39], v[108:111], v[8:11]
    s_waitcnt lgkmcnt(11)
    v_mfma_f32_16x16x32_bf16 v[12:15], v[40:43], v[172:175], v[12:15]
    ds_read_b128 v[32:35], v5 offset:2624
    v_mfma_f32_16x16x32_bf16 v[8:11], v[40:43], v[140:143], v[8:11]
    s_waitcnt lgkmcnt(11)
    v_mfma_f32_16x16x32_bf16 v[12:15], v[44:47], v[204:207], v[12:15]
    ds_read_b128 v[36:39], v5 offset:3136
    v_mfma_f32_16x16x32_bf16 v[8:11], v[44:47], v[172:175], v[8:11]
    s_waitcnt lgkmcnt(8)
    s_nop 0
    v_mfma_f32_16x16x32_bf16 v[12:15], v[48:51], v[236:239], v[12:15]
    ds_read_b128 v[40:43], v5 offset:3648
    ds_read_b128 v[44:47], v5 offset:1152
    v_mfma_f32_16x16x32_bf16 v[8:11], v[48:51], v[204:207], v[8:11]
    ds_read_b128 v[48:51], v5 offset:1664
    v_mfma_f32_16x16x32_bf16 v[12:15], v[52:55], v[80:83], v[12:15]
    ds_read_b128 v[52:55], v5 offset:2176
    s_waitcnt lgkmcnt(11)
    s_nop 0
    ds_read_b64 v[208:209], v4 offset:2112
    ds_read_b64 v[210:211], v4 offset:2120
    v_mfma_f32_16x16x32_bf16 v[12:15], v[56:59], v[112:115], v[12:15]
    v_mfma_f32_16x16x32_bf16 v[8:11], v[56:59], v[80:83], v[8:11]
    s_waitcnt lgkmcnt(12)
    s_waitcnt lgkmcnt(11)
    ds_read_b64 v[240:241], v4 offset:2624
    ds_read_b64 v[242:243], v4 offset:2632
    v_mfma_f32_16x16x32_bf16 v[12:15], v[28:31], v[144:147], v[12:15]
    v_mfma_f32_16x16x32_bf16 v[8:11], v[28:31], v[112:115], v[8:11]
    s_waitcnt lgkmcnt(9)
    s_nop 0
    v_mfma_f32_16x16x32_bf16 v[12:15], v[32:35], v[176:179], v[12:15]
    ds_read_b128 v[56:59], v5 offset:2688
    ds_read_b128 v[28:31], v5 offset:3200
    v_mfma_f32_16x16x32_bf16 v[8:11], v[32:35], v[144:147], v[8:11]
    ds_read_b128 v[32:35], v5 offset:3712
    s_waitcnt lgkmcnt(5)
    s_nop 0
    v_mfma_f32_16x16x32_bf16 v[12:15], v[36:39], v[208:211], v[12:15]
    ds_read_b64 v[212:213], v4 offset:2176
    ds_read_b64 v[214:215], v4 offset:2184
    v_mfma_f32_16x16x32_bf16 v[8:11], v[36:39], v[176:179], v[8:11]
    ds_read_b128 v[36:39], v5 offset:1216
    s_waitcnt lgkmcnt(6)
    s_nop 0
    v_mfma_f32_16x16x32_bf16 v[12:15], v[40:43], v[240:243], v[12:15]
    ds_read_b64 v[244:245], v4 offset:2688
    ds_read_b64 v[246:247], v4 offset:2696
    v_mfma_f32_16x16x32_bf16 v[8:11], v[40:43], v[208:211], v[8:11]
    ds_read_b128 v[40:43], v5 offset:1728
    v_mfma_f32_16x16x32_bf16 v[12:15], v[44:47], v[84:87], v[12:15]
    ds_read_b128 v[44:47], v5 offset:2240
    v_mfma_f32_16x16x32_bf16 v[12:15], v[48:51], v[116:119], v[12:15]
    v_mfma_f32_16x16x32_bf16 v[8:11], v[48:51], v[84:87], v[8:11]
    ds_read_b128 v[48:51], v5 offset:2752
    v_mfma_f32_16x16x32_bf16 v[12:15], v[52:55], v[148:151], v[12:15]
    v_mfma_f32_16x16x32_bf16 v[8:11], v[52:55], v[116:119], v[8:11]
    ds_read_b128 v[52:55], v5 offset:3264
    s_waitcnt lgkmcnt(11)
    v_mfma_f32_16x16x32_bf16 v[12:15], v[56:59], v[180:183], v[12:15]
    v_mfma_f32_16x16x32_bf16 v[8:11], v[56:59], v[148:151], v[8:11]
    ds_read_b128 v[56:59], v5 offset:3776
    s_waitcnt lgkmcnt(8)
    v_mfma_f32_16x16x32_bf16 v[12:15], v[28:31], v[212:215], v[12:15]
    ds_read_b64 v[216:217], v4 offset:2240
    ds_read_b64 v[218:219], v4 offset:2248
    v_mfma_f32_16x16x32_bf16 v[8:11], v[28:31], v[180:183], v[8:11]
    ds_read_b128 v[28:31], v5 offset:1280
    s_waitcnt lgkmcnt(8)
    s_nop 0
    v_mfma_f32_16x16x32_bf16 v[12:15], v[32:35], v[244:247], v[12:15]
    ds_read_b64 v[248:249], v4 offset:2752
    ds_read_b64 v[250:251], v4 offset:2760
    v_mfma_f32_16x16x32_bf16 v[8:11], v[32:35], v[212:215], v[8:11]
    ds_read_b128 v[32:35], v5 offset:1792
    v_mfma_f32_16x16x32_bf16 v[12:15], v[36:39], v[88:91], v[12:15]
    ds_read_b128 v[36:39], v5 offset:2304
    s_waitcnt lgkmcnt(11)
    v_mfma_f32_16x16x32_bf16 v[12:15], v[40:43], v[120:123], v[12:15]
    v_mfma_f32_16x16x32_bf16 v[8:11], v[40:43], v[88:91], v[8:11]
    ds_read_b128 v[40:43], v5 offset:2816
    s_waitcnt lgkmcnt(11)
    v_mfma_f32_16x16x32_bf16 v[12:15], v[44:47], v[152:155], v[12:15]
    v_mfma_f32_16x16x32_bf16 v[8:11], v[44:47], v[120:123], v[8:11]
    ds_read_b128 v[44:47], v5 offset:3328
    s_waitcnt lgkmcnt(11)
    v_mfma_f32_16x16x32_bf16 v[12:15], v[48:51], v[184:187], v[12:15]
    v_mfma_f32_16x16x32_bf16 v[8:11], v[48:51], v[152:155], v[8:11]
    ds_read_b128 v[48:51], v5 offset:3840
    s_waitcnt lgkmcnt(8)
    v_mfma_f32_16x16x32_bf16 v[12:15], v[52:55], v[216:219], v[12:15]
    ds_read_b64 v[60:61], v4 offset:2816
    ds_read_b64 v[62:63], v4 offset:2824
    v_mfma_f32_16x16x32_bf16 v[8:11], v[52:55], v[184:187], v[8:11]
    ds_read_b128 v[52:55], v5 offset:1344
    s_waitcnt lgkmcnt(8)
    s_nop 0
    v_mfma_f32_16x16x32_bf16 v[12:15], v[56:59], v[248:251], v[12:15]
    ds_read_b64 v[220:221], v4 offset:2304
    ds_read_b64 v[222:223], v4 offset:2312
    v_mfma_f32_16x16x32_bf16 v[8:11], v[56:59], v[216:219], v[8:11]
    ds_read_b128 v[56:59], v5 offset:1856
    v_mfma_f32_16x16x32_bf16 v[12:15], v[28:31], v[92:95], v[12:15]
    ds_read_b128 v[28:31], v5 offset:2368
    s_waitcnt lgkmcnt(11)
    v_mfma_f32_16x16x32_bf16 v[12:15], v[32:35], v[124:127], v[12:15]
    v_mfma_f32_16x16x32_bf16 v[8:11], v[32:35], v[92:95], v[8:11]
    ds_read_b128 v[32:35], v5 offset:2880
    s_waitcnt lgkmcnt(11)
    v_mfma_f32_16x16x32_bf16 v[12:15], v[36:39], v[156:159], v[12:15]
    v_mfma_f32_16x16x32_bf16 v[8:11], v[36:39], v[124:127], v[8:11]
    ds_read_b128 v[36:39], v5 offset:3392
    s_waitcnt lgkmcnt(11)
    v_mfma_f32_16x16x32_bf16 v[12:15], v[40:43], v[188:191], v[12:15]
    v_mfma_f32_16x16x32_bf16 v[8:11], v[40:43], v[156:159], v[8:11]
    ds_read_b128 v[40:43], v5 offset:3904
    s_waitcnt lgkmcnt(5)
    v_mfma_f32_16x16x32_bf16 v[12:15], v[44:47], v[220:223], v[12:15]
    ds_read_b64 v[64:65], v4 offset:2880
    ds_read_b64 v[66:67], v4 offset:2888
    v_mfma_f32_16x16x32_bf16 v[8:11], v[44:47], v[188:191], v[8:11]
    ds_read_b128 v[44:47], v5 offset:1408
    v_mfma_f32_16x16x32_bf16 v[12:15], v[48:51], v[60:63], v[12:15]
    ds_read_b64 v[224:225], v4 offset:2368
    ds_read_b64 v[226:227], v4 offset:2376
    v_mfma_f32_16x16x32_bf16 v[8:11], v[48:51], v[220:223], v[8:11]
    ds_read_b128 v[48:51], v5 offset:1920
    v_mfma_f32_16x16x32_bf16 v[12:15], v[52:55], v[96:99], v[12:15]
    ds_read_b128 v[52:55], v5 offset:2432
    s_waitcnt lgkmcnt(11)
    v_mfma_f32_16x16x32_bf16 v[12:15], v[56:59], v[128:131], v[12:15]
    v_mfma_f32_16x16x32_bf16 v[8:11], v[56:59], v[96:99], v[8:11]
    ds_read_b128 v[56:59], v5 offset:2944
    s_waitcnt lgkmcnt(11)
    v_mfma_f32_16x16x32_bf16 v[12:15], v[28:31], v[160:163], v[12:15]
    v_mfma_f32_16x16x32_bf16 v[8:11], v[28:31], v[128:131], v[8:11]
    ds_read_b128 v[28:31], v5 offset:3456
    s_waitcnt lgkmcnt(11)
    v_mfma_f32_16x16x32_bf16 v[12:15], v[32:35], v[192:195], v[12:15]
    v_mfma_f32_16x16x32_bf16 v[8:11], v[32:35], v[160:163], v[8:11]
    ds_read_b128 v[32:35], v5 offset:3968
    s_waitcnt lgkmcnt(5)
    v_mfma_f32_16x16x32_bf16 v[12:15], v[36:39], v[224:227], v[12:15]
    ds_read_b64 v[68:69], v4 offset:2944
    ds_read_b64 v[70:71], v4 offset:2952
    v_mfma_f32_16x16x32_bf16 v[8:11], v[36:39], v[192:195], v[8:11]
    ds_read_b128 v[36:39], v5 offset:1472
    v_mfma_f32_16x16x32_bf16 v[12:15], v[40:43], v[64:67], v[12:15]
    ds_read_b64 v[228:229], v4 offset:2432
    ds_read_b64 v[230:231], v4 offset:2440
    v_mfma_f32_16x16x32_bf16 v[8:11], v[40:43], v[224:227], v[8:11]
    ds_read_b128 v[40:43], v5 offset:1984
    v_mfma_f32_16x16x32_bf16 v[12:15], v[44:47], v[100:103], v[12:15]
    ds_read_b128 v[44:47], v5 offset:2496
    s_waitcnt lgkmcnt(11)
    v_mfma_f32_16x16x32_bf16 v[12:15], v[48:51], v[132:135], v[12:15]
    ds_read_b32 v252, v2 offset:48
    v_mfma_f32_16x16x32_bf16 v[8:11], v[48:51], v[100:103], v[8:11]
    s_waitcnt lgkmcnt(11)
    v_mfma_f32_16x16x32_bf16 v[12:15], v[52:55], v[164:167], v[12:15]
    ds_read_b128 v[48:51], v5 offset:3008
    v_mfma_f32_16x16x32_bf16 v[8:11], v[52:55], v[132:135], v[8:11]
    s_waitcnt lgkmcnt(11)
    v_mfma_f32_16x16x32_bf16 v[12:15], v[56:59], v[196:199], v[12:15]
    ds_read_b128 v[52:55], v5 offset:3520
    v_mfma_f32_16x16x32_bf16 v[8:11], v[56:59], v[164:167], v[8:11]
    s_waitcnt lgkmcnt(5)
    v_mfma_f32_16x16x32_bf16 v[12:15], v[28:31], v[228:231], v[12:15]
    ds_read_b128 v[56:59], v5 offset:4032
    ds_read_b64 v[72:73], v4 offset:3008
    ds_read_b64 v[74:75], v4 offset:3016
    v_mfma_f32_16x16x32_bf16 v[8:11], v[28:31], v[196:199], v[8:11]
    s_waitcnt lgkmcnt(5)
    v_cmp_ne_u32 vcc, 0, v252
    s_cbranch_vccnz Lugd3
Lug3:
    ds_read_b32 v252, v2 offset:48
    s_waitcnt lgkmcnt(0)
    v_cmp_ne_u32 vcc, 0, v252
    s_cbranch_vccz Lug3
Lugd3:
    ds_read_b128 v[28:31], v5 offset:512
    v_mfma_f32_16x16x32_bf16 v[12:15], v[32:35], v[68:71], v[12:15]
    ds_read_b64 v[232:233], v4 offset:2496
    ds_read_b64 v[234:235], v4 offset:2504
    v_mfma_f32_16x16x32_bf16 v[8:11], v[32:35], v[228:231], v[8:11]
    ds_read_b128 v[32:35], v5 offset:1024
    v_mfma_f32_16x16x32_bf16 v[12:15], v[36:39], v[104:107], v[12:15]
    ds_read_b128 v[36:39], v5 offset:1536
    v_mfma_f32_16x16x32_bf16 v[12:15], v[40:43], v[136:139], v[12:15]
    v_mfma_f32_16x16x32_bf16 v[8:11], v[40:43], v[104:107], v[8:11]
    ds_read_b128 v[40:43], v5 offset:2048
    v_mfma_f32_16x16x32_bf16 v[12:15], v[44:47], v[168:171], v[12:15]
    v_mfma_f32_16x16x32_bf16 v[8:11], v[44:47], v[136:139], v[8:11]
    ds_read_b128 v[44:47], v5 offset:2560
    s_waitcnt lgkmcnt(11)
    v_mfma_f32_16x16x32_bf16 v[12:15], v[48:51], v[200:203], v[12:15]
    v_mfma_f32_16x16x32_bf16 v[8:11], v[48:51], v[168:171], v[8:11]
    ds_read_b128 v[48:51], v5 offset:3072
    s_waitcnt lgkmcnt(5)
    v_mfma_f32_16x16x32_bf16 v[12:15], v[52:55], v[232:235], v[12:15]
    ds_read_b64 v[60:61], v4 offset:3072
    ds_read_b64 v[62:63], v4 offset:3080
    v_mfma_f32_16x16x32_bf16 v[8:11], v[52:55], v[200:203], v[8:11]
    ds_read_b128 v[52:55], v5 offset:3584
    ds_read_b64 v[64:65], v4 offset:3584
    ds_read_b64 v[66:67], v4 offset:3592
    v_mfma_f32_16x16x32_bf16 v[12:15], v[56:59], v[72:75], v[12:15]
    v_mfma_f32_16x16x32_bf16 v[8:11], v[56:59], v[232:235], v[8:11]
    ds_read_b128 v[56:59], v5 offset:576
    v_mfma_f32_16x16x32_bf16 v[16:19], v[28:31], v[76:79], 0
    ds_read_b128 v[28:31], v5 offset:1088
    s_waitcnt lgkmcnt(11)
    v_mfma_f32_16x16x32_bf16 v[16:19], v[32:35], v[108:111], v[16:19]
    ds_read_b128 v[32:35], v5 offset:1600
    s_waitcnt lgkmcnt(11)
    v_mfma_f32_16x16x32_bf16 v[16:19], v[36:39], v[140:143], v[16:19]
    s_waitcnt lgkmcnt(8)
    s_nop 0
    v_cvt_pk_bf16_f32 v24, v8, v9
    v_cvt_pk_bf16_f32 v25, v10, v11
    ds_write2_b32 v6, v24, v25 offset0:0 offset1:16
    ds_write_b32 v7, v1 offset:64
    v_cvt_pk_bf16_f32 v26, v12, v13
    v_cvt_pk_bf16_f32 v27, v14, v15
    ds_write2_b32 v6, v26, v27 offset0:128 offset1:144
    ds_write_b32 v7, v1 offset:80
    v_add_u32 v6, 0x400, v6
    v_mfma_f32_16x16x32_bf16 v[20:23], v[40:43], v[204:207], 0
    v_mfma_f32_16x16x32_bf16 v[16:19], v[40:43], v[172:175], v[16:19]
    v_mfma_f32_16x16x32_bf16 v[20:23], v[44:47], v[236:239], v[20:23]
    v_mfma_f32_16x16x32_bf16 v[16:19], v[44:47], v[204:207], v[16:19]
    s_waitcnt lgkmcnt(10)
    s_nop 0
    v_mfma_f32_16x16x32_bf16 v[20:23], v[48:51], v[60:63], v[20:23]
    ds_read_b128 v[36:39], v5 offset:2112
    ds_read_b128 v[40:43], v5 offset:2624
    v_mfma_f32_16x16x32_bf16 v[16:19], v[48:51], v[236:239], v[16:19]
    s_waitcnt lgkmcnt(9)
    s_nop 0
    v_mfma_f32_16x16x32_bf16 v[20:23], v[52:55], v[64:67], v[20:23]
    ds_read_b128 v[44:47], v5 offset:3136
    ds_read_b64 v[68:69], v4 offset:3136
    ds_read_b64 v[70:71], v4 offset:3144
    v_mfma_f32_16x16x32_bf16 v[16:19], v[52:55], v[60:63], v[16:19]
    s_waitcnt lgkmcnt(11)
    v_mfma_f32_16x16x32_bf16 v[16:19], v[56:59], v[80:83], v[16:19]
    ds_read_b128 v[48:51], v5 offset:3648
    s_waitcnt lgkmcnt(11)
    v_mfma_f32_16x16x32_bf16 v[16:19], v[28:31], v[112:115], v[16:19]
    ds_read_b64 v[72:73], v4 offset:3648
    ds_read_b64 v[74:75], v4 offset:3656
    s_waitcnt lgkmcnt(12)
    v_mfma_f32_16x16x32_bf16 v[16:19], v[32:35], v[144:147], v[16:19]
    s_waitcnt lgkmcnt(7)
    v_mfma_f32_16x16x32_bf16 v[20:23], v[36:39], v[208:211], v[20:23]
    ds_read_b128 v[52:55], v5 offset:640
    ds_read_b128 v[56:59], v5 offset:1152
    v_mfma_f32_16x16x32_bf16 v[16:19], v[36:39], v[176:179], v[16:19]
    ds_read_b128 v[28:31], v5 offset:1664
    ds_read_b128 v[32:35], v5 offset:2176
    s_waitcnt lgkmcnt(10)
    s_nop 0
    v_mfma_f32_16x16x32_bf16 v[20:23], v[40:43], v[240:243], v[20:23]
    ds_read_b128 v[36:39], v5 offset:2688
    v_mfma_f32_16x16x32_bf16 v[16:19], v[40:43], v[208:211], v[16:19]
    ds_read_b128 v[40:43], v5 offset:3200
    s_waitcnt lgkmcnt(9)
    s_nop 0
    v_mfma_f32_16x16x32_bf16 v[20:23], v[44:47], v[68:71], v[20:23]
    ds_read_b64 v[60:61], v4 offset:3200
    ds_read_b64 v[62:63], v4 offset:3208
    v_mfma_f32_16x16x32_bf16 v[16:19], v[44:47], v[240:243], v[16:19]
    ds_read_b128 v[44:47], v5 offset:3712
    s_waitcnt lgkmcnt(9)
    s_nop 0
    v_mfma_f32_16x16x32_bf16 v[20:23], v[48:51], v[72:75], v[20:23]
    ds_read_b64 v[64:65], v4 offset:3712
    ds_read_b64 v[66:67], v4 offset:3720
    v_mfma_f32_16x16x32_bf16 v[16:19], v[48:51], v[68:71], v[16:19]
    ds_read_b128 v[48:51], v5 offset:704
    s_waitcnt lgkmcnt(11)
    v_mfma_f32_16x16x32_bf16 v[16:19], v[52:55], v[84:87], v[16:19]
    ds_read_b128 v[52:55], v5 offset:1216
    s_waitcnt lgkmcnt(11)
    v_mfma_f32_16x16x32_bf16 v[16:19], v[56:59], v[116:119], v[16:19]
    ds_read_b128 v[56:59], v5 offset:1728
    s_waitcnt lgkmcnt(11)
    v_mfma_f32_16x16x32_bf16 v[16:19], v[28:31], v[148:151], v[16:19]
    ds_read_b128 v[28:31], v5 offset:2240
    s_waitcnt lgkmcnt(11)
    v_mfma_f32_16x16x32_bf16 v[20:23], v[32:35], v[212:215], v[20:23]
    v_mfma_f32_16x16x32_bf16 v[16:19], v[32:35], v[180:183], v[16:19]
    ds_read_b128 v[32:35], v5 offset:2752
    s_waitcnt lgkmcnt(11)
    v_mfma_f32_16x16x32_bf16 v[20:23], v[36:39], v[244:247], v[20:23]
    v_mfma_f32_16x16x32_bf16 v[16:19], v[36:39], v[212:215], v[16:19]
    ds_read_b128 v[36:39], v5 offset:3264
    s_waitcnt lgkmcnt(9)
    v_mfma_f32_16x16x32_bf16 v[20:23], v[40:43], v[60:63], v[20:23]
    ds_read_b64 v[68:69], v4 offset:3264
    ds_read_b64 v[70:71], v4 offset:3272
    v_mfma_f32_16x16x32_bf16 v[16:19], v[40:43], v[244:247], v[16:19]
    ds_read_b128 v[40:43], v5 offset:3776
    s_waitcnt lgkmcnt(9)
    s_nop 0
    v_mfma_f32_16x16x32_bf16 v[20:23], v[44:47], v[64:67], v[20:23]
    ds_read_b64 v[72:73], v4 offset:3776
    ds_read_b64 v[74:75], v4 offset:3784
    v_mfma_f32_16x16x32_bf16 v[16:19], v[44:47], v[60:63], v[16:19]
    ds_read_b128 v[44:47], v5 offset:768
    s_waitcnt lgkmcnt(11)
    v_mfma_f32_16x16x32_bf16 v[16:19], v[48:51], v[88:91], v[16:19]
    ds_read_b128 v[48:51], v5 offset:1280
    s_waitcnt lgkmcnt(11)
    v_mfma_f32_16x16x32_bf16 v[16:19], v[52:55], v[120:123], v[16:19]
    ds_read_b128 v[52:55], v5 offset:1792
    s_waitcnt lgkmcnt(11)
    v_mfma_f32_16x16x32_bf16 v[16:19], v[56:59], v[152:155], v[16:19]
    ds_read_b128 v[56:59], v5 offset:2304
    s_waitcnt lgkmcnt(11)
    v_mfma_f32_16x16x32_bf16 v[20:23], v[28:31], v[216:219], v[20:23]
    v_mfma_f32_16x16x32_bf16 v[16:19], v[28:31], v[184:187], v[16:19]
    ds_read_b128 v[28:31], v5 offset:2816
    s_waitcnt lgkmcnt(11)
    s_nop 0
    v_mfma_f32_16x16x32_bf16 v[20:23], v[32:35], v[248:251], v[20:23]
    ds_read_b64 v[60:61], v4 offset:2816
    ds_read_b64 v[62:63], v4 offset:2824
    v_mfma_f32_16x16x32_bf16 v[16:19], v[32:35], v[216:219], v[16:19]
    s_waitcnt lgkmcnt(10)
    s_nop 0
    v_mfma_f32_16x16x32_bf16 v[20:23], v[36:39], v[68:71], v[20:23]
    ds_read_b128 v[32:35], v5 offset:3328
    ds_read_b64 v[64:65], v4 offset:3328
    ds_read_b64 v[66:67], v4 offset:3336
    v_mfma_f32_16x16x32_bf16 v[16:19], v[36:39], v[248:251], v[16:19]
    s_waitcnt lgkmcnt(10)
    s_nop 0
    v_mfma_f32_16x16x32_bf16 v[20:23], v[40:43], v[72:75], v[20:23]
    ds_read_b128 v[36:39], v5 offset:3840
    v_mfma_f32_16x16x32_bf16 v[16:19], v[40:43], v[68:71], v[16:19]
    ds_read_b64 v[68:69], v4 offset:3840
    ds_read_b64 v[70:71], v4 offset:3848
    s_waitcnt lgkmcnt(12)
    v_mfma_f32_16x16x32_bf16 v[16:19], v[44:47], v[92:95], v[16:19]
    s_waitcnt lgkmcnt(11)
    v_mfma_f32_16x16x32_bf16 v[16:19], v[48:51], v[124:127], v[16:19]
    ds_read_b128 v[40:43], v5 offset:832
    s_waitcnt lgkmcnt(11)
    v_mfma_f32_16x16x32_bf16 v[16:19], v[52:55], v[156:159], v[16:19]
    ds_read_b128 v[44:47], v5 offset:1344
    s_waitcnt lgkmcnt(11)
    v_mfma_f32_16x16x32_bf16 v[20:23], v[56:59], v[220:223], v[20:23]
    ds_read_b128 v[48:51], v5 offset:1856
    v_mfma_f32_16x16x32_bf16 v[16:19], v[56:59], v[188:191], v[16:19]
    s_waitcnt lgkmcnt(9)
    s_nop 0
    v_mfma_f32_16x16x32_bf16 v[20:23], v[28:31], v[60:63], v[20:23]
    ds_read_b128 v[52:55], v5 offset:2368
    ds_read_b128 v[56:59], v5 offset:2880
    v_mfma_f32_16x16x32_bf16 v[16:19], v[28:31], v[220:223], v[16:19]
    ds_read_b64 v[72:73], v4 offset:2880
    ds_read_b64 v[74:75], v4 offset:2888
    s_waitcnt lgkmcnt(10)
    s_nop 0
    v_mfma_f32_16x16x32_bf16 v[20:23], v[32:35], v[64:67], v[20:23]
    ds_read_b128 v[28:31], v5 offset:3392
    v_mfma_f32_16x16x32_bf16 v[16:19], v[32:35], v[60:63], v[16:19]
    ds_read_b64 v[60:61], v4 offset:3392
    ds_read_b64 v[62:63], v4 offset:3400
    s_waitcnt lgkmcnt(10)
    s_nop 0
    v_mfma_f32_16x16x32_bf16 v[20:23], v[36:39], v[68:71], v[20:23]
    ds_read_b128 v[32:35], v5 offset:3904
    v_mfma_f32_16x16x32_bf16 v[16:19], v[36:39], v[64:67], v[16:19]
    ds_read_b64 v[64:65], v4 offset:3904
    ds_read_b64 v[66:67], v4 offset:3912
    s_waitcnt lgkmcnt(12)
    v_mfma_f32_16x16x32_bf16 v[16:19], v[40:43], v[96:99], v[16:19]
    s_waitcnt lgkmcnt(11)
    v_mfma_f32_16x16x32_bf16 v[16:19], v[44:47], v[128:131], v[16:19]
    ds_read_b128 v[36:39], v5 offset:896
    s_waitcnt lgkmcnt(11)
    v_mfma_f32_16x16x32_bf16 v[16:19], v[48:51], v[160:163], v[16:19]
    ds_read_b128 v[40:43], v5 offset:1408
    s_waitcnt lgkmcnt(11)
    v_mfma_f32_16x16x32_bf16 v[20:23], v[52:55], v[224:227], v[20:23]
    ds_read_b128 v[44:47], v5 offset:1920
    v_mfma_f32_16x16x32_bf16 v[16:19], v[52:55], v[192:195], v[16:19]
    s_waitcnt lgkmcnt(9)
    s_nop 0
    v_mfma_f32_16x16x32_bf16 v[20:23], v[56:59], v[72:75], v[20:23]
    ds_read_b128 v[48:51], v5 offset:2432
    ds_read_b128 v[52:55], v5 offset:2944
    v_mfma_f32_16x16x32_bf16 v[16:19], v[56:59], v[224:227], v[16:19]
    ds_read_b64 v[68:69], v4 offset:2944
    ds_read_b64 v[70:71], v4 offset:2952
    s_waitcnt lgkmcnt(10)
    s_nop 0
    v_mfma_f32_16x16x32_bf16 v[20:23], v[28:31], v[60:63], v[20:23]
    ds_read_b128 v[56:59], v5 offset:3456
    v_mfma_f32_16x16x32_bf16 v[16:19], v[28:31], v[72:75], v[16:19]
    ds_read_b64 v[72:73], v4 offset:3456
    ds_read_b64 v[74:75], v4 offset:3464
    s_waitcnt lgkmcnt(10)
    s_nop 0
    v_mfma_f32_16x16x32_bf16 v[20:23], v[32:35], v[64:67], v[20:23]
    ds_read_b128 v[28:31], v5 offset:3968
    v_mfma_f32_16x16x32_bf16 v[16:19], v[32:35], v[60:63], v[16:19]
    ds_read_b64 v[60:61], v4 offset:3968
    ds_read_b64 v[62:63], v4 offset:3976
    s_waitcnt lgkmcnt(12)
    v_mfma_f32_16x16x32_bf16 v[16:19], v[36:39], v[100:103], v[16:19]
    s_waitcnt lgkmcnt(11)
    v_mfma_f32_16x16x32_bf16 v[16:19], v[40:43], v[132:135], v[16:19]
    ds_read_b128 v[32:35], v5 offset:960
    s_waitcnt lgkmcnt(11)
    v_mfma_f32_16x16x32_bf16 v[16:19], v[44:47], v[164:167], v[16:19]
    ds_read_b128 v[36:39], v5 offset:1472
    s_waitcnt lgkmcnt(11)
    v_mfma_f32_16x16x32_bf16 v[20:23], v[48:51], v[228:231], v[20:23]
    ds_read_b128 v[40:43], v5 offset:1984
    v_mfma_f32_16x16x32_bf16 v[16:19], v[48:51], v[196:199], v[16:19]
    s_waitcnt lgkmcnt(9)
    s_nop 0
    v_mfma_f32_16x16x32_bf16 v[20:23], v[52:55], v[68:71], v[20:23]
    ds_read_b128 v[44:47], v5 offset:2496
    ds_read_b128 v[48:51], v5 offset:3008
    v_mfma_f32_16x16x32_bf16 v[16:19], v[52:55], v[228:231], v[16:19]
    ds_read_b64 v[64:65], v4 offset:3008
    ds_read_b64 v[66:67], v4 offset:3016
    s_waitcnt lgkmcnt(10)
    s_nop 0
    v_mfma_f32_16x16x32_bf16 v[20:23], v[56:59], v[72:75], v[20:23]
    ds_read_b128 v[52:55], v5 offset:3520
    v_mfma_f32_16x16x32_bf16 v[16:19], v[56:59], v[68:71], v[16:19]
    ds_read_b64 v[68:69], v4 offset:3520
    ds_read_b64 v[70:71], v4 offset:3528
    s_waitcnt lgkmcnt(10)
    s_nop 0
    v_mfma_f32_16x16x32_bf16 v[20:23], v[28:31], v[60:63], v[20:23]
    ds_read_b128 v[56:59], v5 offset:4032
    v_mfma_f32_16x16x32_bf16 v[16:19], v[28:31], v[72:75], v[16:19]
    ds_read_b64 v[72:73], v4 offset:4032
    ds_read_b64 v[74:75], v4 offset:4040
    s_waitcnt lgkmcnt(12)
    v_mfma_f32_16x16x32_bf16 v[16:19], v[32:35], v[104:107], v[16:19]
    s_waitcnt lgkmcnt(11)
    v_mfma_f32_16x16x32_bf16 v[16:19], v[36:39], v[136:139], v[16:19]
    ds_read_b128 v[28:31], v5 offset:0
    s_waitcnt lgkmcnt(11)
    v_mfma_f32_16x16x32_bf16 v[16:19], v[40:43], v[168:171], v[16:19]
    ds_read_b128 v[32:35], v5 offset:512
    s_waitcnt lgkmcnt(11)
    v_mfma_f32_16x16x32_bf16 v[20:23], v[44:47], v[232:235], v[20:23]
    ds_read_b128 v[36:39], v5 offset:1024
    v_mfma_f32_16x16x32_bf16 v[16:19], v[44:47], v[200:203], v[16:19]
    s_waitcnt lgkmcnt(9)
    s_nop 0
    v_mfma_f32_16x16x32_bf16 v[20:23], v[48:51], v[64:67], v[20:23]
    ds_read_b128 v[40:43], v5 offset:1536
    ds_read_b128 v[44:47], v5 offset:64
    v_mfma_f32_16x16x32_bf16 v[16:19], v[48:51], v[232:235], v[16:19]
    ds_read_b128 v[48:51], v5 offset:576
    s_waitcnt lgkmcnt(9)
    v_mfma_f32_16x16x32_bf16 v[20:23], v[52:55], v[68:71], v[20:23]
    v_mfma_f32_16x16x32_bf16 v[16:19], v[52:55], v[64:67], v[16:19]
    ds_read_b128 v[52:55], v5 offset:1088
    s_waitcnt lgkmcnt(7)
    v_mfma_f32_16x16x32_bf16 v[20:23], v[56:59], v[72:75], v[20:23]
    v_mfma_f32_16x16x32_bf16 v[16:19], v[56:59], v[68:71], v[16:19]
    ds_read_b128 v[56:59], v5 offset:1600
    s_waitcnt lgkmcnt(7)
    v_mfma_f32_16x16x32_bf16 v[20:23], v[28:31], v[76:79], v[20:23]
    ds_read_b128 v[28:31], v5 offset:128
    s_waitcnt lgkmcnt(7)
    v_mfma_f32_16x16x32_bf16 v[20:23], v[32:35], v[108:111], v[20:23]
    ds_read_b128 v[32:35], v5 offset:640
    s_waitcnt lgkmcnt(7)
    s_nop 0
    v_mfma_f32_16x16x32_bf16 v[20:23], v[36:39], v[140:143], v[20:23]
    v_cvt_pk_bf16_f32 v24, v16, v17
    v_cvt_pk_bf16_f32 v25, v18, v19
    ds_write2_b32 v6, v24, v25 offset0:0 offset1:16
    ds_write_b32 v7, v1 offset:96
    ds_read_b128 v[36:39], v5 offset:1152
    s_waitcnt lgkmcnt(9)
    v_mfma_f32_16x16x32_bf16 v[20:23], v[40:43], v[172:175], v[20:23]
    ds_read_b128 v[40:43], v5 offset:1664
    s_waitcnt lgkmcnt(9)
    v_mfma_f32_16x16x32_bf16 v[20:23], v[44:47], v[80:83], v[20:23]
    ds_read_b128 v[44:47], v5 offset:192
    s_waitcnt lgkmcnt(9)
    v_mfma_f32_16x16x32_bf16 v[20:23], v[48:51], v[112:115], v[20:23]
    ds_read_b128 v[48:51], v5 offset:704
    s_waitcnt lgkmcnt(9)
    v_mfma_f32_16x16x32_bf16 v[20:23], v[52:55], v[144:147], v[20:23]
    ds_read_b128 v[52:55], v5 offset:1216
    s_waitcnt lgkmcnt(9)
    v_mfma_f32_16x16x32_bf16 v[20:23], v[56:59], v[176:179], v[20:23]
    ds_read_b128 v[56:59], v5 offset:1728
    s_waitcnt lgkmcnt(9)
    v_mfma_f32_16x16x32_bf16 v[20:23], v[28:31], v[84:87], v[20:23]
    ds_read_b128 v[28:31], v5 offset:256
    s_waitcnt lgkmcnt(9)
    v_mfma_f32_16x16x32_bf16 v[20:23], v[32:35], v[116:119], v[20:23]
    ds_read_b128 v[32:35], v5 offset:768
    s_waitcnt lgkmcnt(7)
    v_mfma_f32_16x16x32_bf16 v[20:23], v[36:39], v[148:151], v[20:23]
    ds_read_b128 v[36:39], v5 offset:1280
    s_waitcnt lgkmcnt(7)
    v_mfma_f32_16x16x32_bf16 v[20:23], v[40:43], v[180:183], v[20:23]
    ds_read_b128 v[40:43], v5 offset:1792
    s_waitcnt lgkmcnt(7)
    v_mfma_f32_16x16x32_bf16 v[20:23], v[44:47], v[88:91], v[20:23]
    ds_read_b128 v[44:47], v5 offset:320
    s_waitcnt lgkmcnt(7)
    v_mfma_f32_16x16x32_bf16 v[20:23], v[48:51], v[120:123], v[20:23]
    ds_read_b128 v[48:51], v5 offset:832
    s_waitcnt lgkmcnt(7)
    v_mfma_f32_16x16x32_bf16 v[20:23], v[52:55], v[152:155], v[20:23]
    ds_read_b128 v[52:55], v5 offset:1344
    s_waitcnt lgkmcnt(7)
    v_mfma_f32_16x16x32_bf16 v[20:23], v[56:59], v[184:187], v[20:23]
    ds_read_b128 v[56:59], v5 offset:1856
    s_waitcnt lgkmcnt(7)
    v_mfma_f32_16x16x32_bf16 v[20:23], v[28:31], v[92:95], v[20:23]
    ds_read_b128 v[28:31], v5 offset:384
    s_waitcnt lgkmcnt(7)
    v_mfma_f32_16x16x32_bf16 v[20:23], v[32:35], v[124:127], v[20:23]
    ds_read_b128 v[32:35], v5 offset:896
    s_waitcnt lgkmcnt(7)
    v_mfma_f32_16x16x32_bf16 v[20:23], v[36:39], v[156:159], v[20:23]
    ds_read_b128 v[36:39], v5 offset:1408
    s_waitcnt lgkmcnt(7)
    v_mfma_f32_16x16x32_bf16 v[20:23], v[40:43], v[188:191], v[20:23]
    ds_read_b128 v[40:43], v5 offset:1920
    s_waitcnt lgkmcnt(7)
    v_mfma_f32_16x16x32_bf16 v[20:23], v[44:47], v[96:99], v[20:23]
    ds_read_b128 v[44:47], v5 offset:448
    s_waitcnt lgkmcnt(7)
    v_mfma_f32_16x16x32_bf16 v[20:23], v[48:51], v[128:131], v[20:23]
    ds_read_b128 v[48:51], v5 offset:960
    s_waitcnt lgkmcnt(7)
    v_mfma_f32_16x16x32_bf16 v[20:23], v[52:55], v[160:163], v[20:23]
    ds_read_b128 v[52:55], v5 offset:1472
    s_waitcnt lgkmcnt(7)
    v_mfma_f32_16x16x32_bf16 v[20:23], v[56:59], v[192:195], v[20:23]
    ds_read_b128 v[56:59], v5 offset:1984
    s_waitcnt lgkmcnt(7)
    v_mfma_f32_16x16x32_bf16 v[20:23], v[28:31], v[100:103], v[20:23]
    s_waitcnt lgkmcnt(6)
    v_mfma_f32_16x16x32_bf16 v[20:23], v[32:35], v[132:135], v[20:23]
    s_waitcnt lgkmcnt(5)
    v_mfma_f32_16x16x32_bf16 v[20:23], v[36:39], v[164:167], v[20:23]
    s_waitcnt lgkmcnt(4)
    v_mfma_f32_16x16x32_bf16 v[20:23], v[40:43], v[196:199], v[20:23]
    s_waitcnt lgkmcnt(3)
    v_mfma_f32_16x16x32_bf16 v[20:23], v[44:47], v[104:107], v[20:23]
    s_waitcnt lgkmcnt(2)
    v_mfma_f32_16x16x32_bf16 v[20:23], v[48:51], v[136:139], v[20:23]
    s_waitcnt lgkmcnt(1)
    v_mfma_f32_16x16x32_bf16 v[20:23], v[52:55], v[168:171], v[20:23]
    s_waitcnt lgkmcnt(0)
    v_mfma_f32_16x16x32_bf16 v[20:23], v[56:59], v[200:203], v[20:23]
    s_nop 7
    v_cvt_pk_bf16_f32 v26, v20, v21
    v_cvt_pk_bf16_f32 v27, v22, v23
    ds_write2_b32 v6, v26, v27 offset0:128 offset1:144
    ds_write_b32 v7, v1 offset:112
Lend:
    s_endpgm
.section .rodata,"a"
.p2align 6
.amdhsa_kernel gated_mix__ssm_conv_s4d__ssm_conv_h3__prompt_kernel
  .amdhsa_next_free_vgpr 256
  .amdhsa_next_free_sgpr 102
  .amdhsa_accum_offset 256
  .amdhsa_group_segment_fixed_size 0
  .amdhsa_kernarg_size 136
  .amdhsa_user_sgpr_count 2
  .amdhsa_user_sgpr_kernarg_segment_ptr 1
  .amdhsa_system_sgpr_workgroup_id_x 1
  .amdhsa_float_denorm_mode_32 3
.end_amdhsa_kernel
```
